```python
import torch

def _softmax(x, axis=-1):
    return torch.softmax(x, dim=axis)
def _gelu(x):
    return torch.nn.functional.gelu(x, approximate="tanh")
def _silu(x):
    return torch.nn.functional.silu(x)
def _sigmoid(x):
    return torch.sigmoid(x)
def _layernorm(x, axis=-1, eps=1e-5):
    m = x.mean(dim=axis, keepdim=True)
    v = x.var(dim=axis, keepdim=True, unbiased=False)
    return (x - m) / torch.sqrt(v + eps)
def _scatter_add(tgt, idx, src, axis=0):
    return tgt.clone().index_add_(axis, idx, src)
def _segment_sum(src, seg, n):
    out = torch.zeros((n,) + src.shape[1:], dtype=src.dtype)
    return out.index_add_(0, seg, src)
def _pad(x, pw):
    flat = tuple(v for pair in reversed(pw) for v in pair)
    return torch.nn.functional.pad(x, flat)

kernel_name = 'parallel_sum__softmax_full_mha__dense_activation_gelu__prompt'

def setup_inputs():

    _w = (lambda a: (lambda t: t.to(torch.bfloat16) if t.is_floating_point() else t)(torch.as_tensor(a)))
    def _A_setup():
        B, S, D = 1, 2048, 512
        return {
            "x": _w((lambda *s: torch.randn(*s, dtype=torch.bfloat16) * 0.05)(B, S, D)),
            "wqkv": _w((lambda *s: torch.randn(*s, dtype=torch.bfloat16) * 0.05)(D, 3 * D)),
            "wo": _w((lambda *s: torch.randn(*s, dtype=torch.bfloat16) * 0.05)(D, D)),
        }
    _A_in = _A_setup()

    def _B_setup():
        B, S, D, F = 1, 2048, 512, 1792
        return {
            "x": _w((lambda *s: torch.randn(*s, dtype=torch.bfloat16) * 0.05)(B, S, D)),
            "w1": _w((lambda *s: torch.randn(*s, dtype=torch.bfloat16) * 0.8)(D, F) * (D ** -0.5)),
            "b1": _w((lambda *s: torch.randn(*s, dtype=torch.bfloat16) * 12.8)(F) * 0.01),
            "w2": _w((lambda *s: torch.randn(*s, dtype=torch.bfloat16) * 0.8)(F, D) * (F ** -0.5)),
            "b2": _w((lambda *s: torch.randn(*s, dtype=torch.bfloat16) * 12.8)(D) * 0.01),
        }
    _B_in = _B_setup()

    return {
        "A_x": _A_in["x"],
        "A_wqkv": _A_in["wqkv"],
        "A_wo": _A_in["wo"],
        "B_x": _B_in["x"],
        "B_w1": _B_in["w1"],
        "B_b1": _B_in["b1"],
        "B_w2": _B_in["w2"],
        "B_b2": _B_in["b2"],
    }

def reference(A_x, A_wqkv, A_wo, B_x, B_w1, B_b1, B_w2, B_b2):
    def _A_ref(x, wqkv, wo):
        B, S, D = x.shape
        H = 32; Dh = D // H
        qkv = (lambda x, *d: x.permute(*d))((x @ wqkv).reshape(B, S, 3, H, Dh), 2, 0, 3, 1, 4)
        q, k, v = qkv[0], qkv[1], qkv[2]
        scale = Dh ** -0.5
        scores = torch.einsum("bhqd,bhkd->bhqk", q, k) * scale
        p = _softmax(scores, axis=-1)
        o = torch.einsum("bhqk,bhkd->bhqd", p, v)
        return (lambda x, *d: x.permute(*d))(o, 0, 2, 1, 3).reshape(B, S, D) @ wo

    def _B_ref(x, w1, b1, w2, b2):
        h = torch.einsum("bsd,df->bsf", x, w1) + b1
        h = _gelu(h)
        return torch.einsum("bsf,fd->bsd", h, w2) + b2

    x = A_x
    xn = _layernorm(x, axis=-1)
    return x + _A_ref(xn, A_wqkv, A_wo) + _B_ref(xn, B_w1, B_b1, B_w2, B_b2)
```

```asm
; @launch kernel=parallel_sum__softmax_full_mha__dense_activation_gelu__prompt_kernel grid=(256,1,1) block=(512,1,1) lds=163840
.amdgcn_target "amdgcn-amd-amdhsa--gfx950"
.text
.globl parallel_sum__softmax_full_mha__dense_activation_gelu__prompt_kernel
.p2align 8
.type parallel_sum__softmax_full_mha__dense_activation_gelu__prompt_kernel,@function
parallel_sum__softmax_full_mha__dense_activation_gelu__prompt_kernel:
    s_cmp_ge_u32 s2, 256
    s_cbranch_scc1 L_end
    s_load_dwordx16 s[4:19], s[0:1], 0
    s_load_dwordx4 s[20:23], s[0:1], 64
    s_load_dwordx2 s[24:25], s[0:1], 80
    s_getpc_b64 s[44:45]
L_pc:
    s_mov_b32 s46, L_code_end-L_pc
    s_mov_b32 s47, 0x00020000
    v_lshlrev_b32 v5, 6, v0
    buffer_load_dword v253, v5, s[44:47], 0 offen
    v_and_b32 v1, 63, v0
    v_lshrrev_b32 v2, 6, v0
    v_lshlrev_b32 v3, 4, v1
    v_readfirstlane_b32 s64, v2
    v_mov_b32 v4, 0
    s_and_b32 s74, s2, 7
    s_lshr_b32 s75, s2, 3
    s_and_b32 s70, s75, 7
    s_and_b32 s77, s74, 1
    s_lshl_b32 s77, s77, 3
    s_add_u32 s66, s77, s70
    s_lshr_b32 s77, s75, 3
    s_lshr_b32 s68, s77, 1
    s_and_b32 s78, s77, 1
    s_and_b32 s67, s74, 6
    s_add_u32 s67, s67, s78
    s_lshl_b32 s74, s74, 2
    s_add_u32 s69, s74, s77
    s_and_b32 s78, s75, 3
    s_add_u32 s71, s74, s78
    s_lshr_b32 s72, s75, 2
    s_mov_b32 s73, s70
    s_and_b32 s65, s64, 3
    s_mov_b32 s30, 25165824
    s_mov_b32 s31, 0x00020000
    s_mov_b32 s3, 20971520
    v_and_b32 v2, 31, v1
    v_lshrrev_b32 v7, 5, v1
    s_cmp_lt_u32 s64, 4
    s_cbranch_scc1 L_m
    s_branch L_h
L_dma:
    s_lshl_b32 s74, s73, 7
    s_add_u32 s75, s74, 16384
    s_mul_i32 s76, s73, s97
    s_cmp_lg_u32 s68, 0
    s_cbranch_scc1 L_dma_ffn
    s_add_u32 m0, s92, 0
    s_nop 0
    buffer_load_dwordx4 v224, s[32:35], s74 offen lds
    s_add_u32 m0, s93, 0
    s_nop 0
    buffer_load_dwordx4 v226, s[36:39], s76 offen offset:0 lds
    s_add_u32 m0, s93, 4032
    s_nop 0
    buffer_load_dwordx4 v226, s[36:39], s76 offen offset:64 lds
    s_add_u32 m0, s92, 1024
    s_nop 0
    buffer_load_dwordx4 v225, s[32:35], s74 offen lds
    s_add_u32 m0, s93, 7168
    s_nop 0
    buffer_load_dwordx4 v226, s[36:39], s76 offen offset:1024 lds
    s_add_u32 m0, s93, 11200
    s_nop 0
    buffer_load_dwordx4 v226, s[36:39], s76 offen offset:1088 lds
    s_add_u32 m0, s92, 2048
    s_nop 0
    buffer_load_dwordx4 v224, s[32:35], s75 offen lds
    s_add_u32 m0, s93, 14336
    s_nop 0
    buffer_load_dwordx4 v226, s[36:39], s76 offen offset:2048 lds
    s_add_u32 m0, s93, 18368
    s_nop 0
    buffer_load_dwordx4 v226, s[36:39], s76 offen offset:2112 lds
    s_add_u32 m0, s92, 3072
    s_nop 0
    buffer_load_dwordx4 v225, s[32:35], s75 offen lds
    s_branch L_dma_adv
L_dma_ffn:
    s_add_u32 m0, s92, 0
    s_nop 0
    buffer_load_dwordx4 v224, s[32:35], s74 offen lds
    s_add_u32 m0, s93, 0
    s_nop 0
    buffer_load_dwordx4 v226, s[36:39], s76 offen offset:0 lds
    s_add_u32 m0, s93, 4032
    s_nop 0
    buffer_load_dwordx4 v226, s[36:39], s76 offen offset:64 lds
    s_add_u32 m0, s92, 1024
    s_nop 0
    buffer_load_dwordx4 v225, s[32:35], s74 offen lds
    s_add_u32 m0, s93, 8064
    s_nop 0
    buffer_load_dwordx4 v226, s[36:39], s76 offen offset:128 lds
    s_add_u32 m0, s93, 12096
    s_nop 0
    buffer_load_dwordx4 v226, s[36:39], s76 offen offset:192 lds
    s_add_u32 m0, s92, 2048
    s_nop 0
    buffer_load_dwordx4 v224, s[32:35], s75 offen lds
    s_add_u32 m0, s93, 16128
    s_nop 0
    buffer_load_dwordx4 v226, s[36:39], s76 offen offset:256 lds
    s_add_u32 m0, s93, 20160
    s_nop 0
    buffer_load_dwordx4 v226, s[36:39], s76 offen offset:320 lds
    s_add_u32 m0, s92, 3072
    s_nop 0
    buffer_load_dwordx4 v225, s[32:35], s75 offen lds
    s_add_u32 m0, s93, 24192
    s_nop 0
    buffer_load_dwordx4 v226, s[36:39], s76 offen offset:384 lds
L_dma_adv:
    s_add_u32 s73, s73, 1
    s_and_b32 s73, s73, 7
    s_add_u32 s95, s95, 1
    s_cmp_eq_u32 s95, 3
    s_cselect_b32 s95, 0, s95
    s_cselect_b32 s74, -32768, s98
    s_cselect_b32 s75, -57344, s99
    s_add_u32 s92, s92, s74
    s_add_u32 s93, s93, s75
    s_setpc_b64 s[100:101]
L_h:
    v_lshrrev_b32 v8, 3, v1
    s_lshl_b32 s74, s65, 5
    v_add_u32 v8, s74, v8
    v_lshlrev_b32 v8, 10, v8
    v_and_b32 v9, 7, v1
    v_lshrrev_b32 v10, 4, v1
    v_xor_b32 v9, v9, v10
    v_lshl_add_u32 v224, v9, 4, v8
    v_xor_b32 v9, 4, v9
    v_lshl_add_u32 v225, v9, 4, v8
    v_add_u32 v225, 0x2000, v225
    v_lshrrev_b32 v8, 2, v1
    s_lshl_b32 s74, s65, 4
    v_add_u32 v8, s74, v8
    v_and_b32 v9, 3, v1
    v_lshlrev_b32 v9, 4, v9
    s_mov_b32 s34, 0x20000
    s_mov_b32 s35, 0x00020000
    s_mov_b32 s39, 0x00020000
    s_lshl_b32 s75, s66, 17
    s_lshl_b32 s92, s65, 12
    s_lshl_b32 s93, s65, 10
    s_add_u32 s93, s93, 49152
    s_mov_b32 s95, 0
    s_mov_b32 s98, 16384
    s_mov_b32 s99, 28672
    s_lshl_b32 s96, s73, 9
    s_lshl_b32 s94, s68, 3
    s_add_u32 s94, s94, s67
    s_lshl_b32 s79, s67, 2
    s_add_u32 s79, s79, s65
    s_lshl_b32 s79, s79, 12
    s_movk_i32 s76, 3072
    s_movk_i32 s74, 128
    s_cmp_lg_u32 s68, 0
    s_cselect_b32 s76, 3584, s76
    s_cselect_b32 s74, 448, s74
    s_cselect_b32 s42, s76, 0
    s_mul_i32 s74, s74, s67
    s_lshl_b32 s97, s76, 6
    s_lshl_b32 s38, s76, 9
    s_sub_u32 s38, s38, s74
    v_mul_lo_u32 v226, v8, s76
    v_add_u32 v226, v226, v9
    s_cmp_lg_u32 s68, 0
    s_waitcnt lgkmcnt(0)
    s_cselect_b32 s36, s12, s6
    s_cselect_b32 s37, s13, s7
    s_add_u32 s36, s36, s74
    s_addc_u32 s37, s37, 0
    s_mov_b32 s28, s24
    s_mov_b32 s29, s25
    s_add_u32 s32, s4, s75
    s_addc_u32 s33, s5, 0
    buffer_load_dwordx2 v[230:231], v4, s[28:31], s3 offen sc1
    s_cmp_lg_u32 s68, 0
    s_cbranch_scc1 L_h_rows
    s_call_b64 s[100:101], L_dma
    s_branch L_h_su
L_h_rows:
    buffer_load_dwordx4 v[96:99], v3, s[32:35], s79 offen
    buffer_load_dwordx4 v[100:103], v3, s[32:35], s79 offen offset:1024
    buffer_load_dwordx4 v[104:107], v3, s[32:35], s79 offen offset:2048
    buffer_load_dwordx4 v[108:111], v3, s[32:35], s79 offen offset:3072
L_h_su:
    v_lshlrev_b32 v227, 3, v7
    v_bfe_u32 v8, v1, 2, 2
    v_add_u32 v227, v227, v8
    v_lshlrev_b32 v227, 6, v227
    v_bfe_u32 v8, v1, 4, 1
    v_lshl_add_u32 v227, v8, 5, v227
    v_and_b32 v8, 3, v1
    v_lshl_add_u32 v227, v8, 3, v227
    s_lshl_b32 s74, s65, 12
    s_add_u32 s75, s74, 49152
    v_add_u32 v227, s75, v227
    s_lshl_b32 s75, s94, 1
    s_lshr_b32 s76, s66, 3
    s_add_u32 s75, s75, s76
    s_lshl_b32 s75, s75, 14
    s_add_u32 s75, s75, s74
    s_add_u32 s75, s75, 22544384
    v_lshl_add_u32 v229, v1, 3, s75
    s_lshl_b32 s74, s66, 2
    s_add_u32 s74, s74, s65
    s_lshl_b32 s74, s74, 9
    s_add_u32 s74, s74, 22020096
    v_lshl_add_u32 v228, v2, 4, s74
    v_mov_b32 v8, 159808
    v_lshl_add_u32 v8, v2, 2, v8
    v_mov_b32 v9, 4
    v_cmp_eq_u32 vcc, 8, v2
    s_mov_b32 s40, s14
    s_mov_b32 s41, s15
    v_cndmask_b32 v9, 0, v9, vcc
    ds_write_b32 v8, v9
    s_mov_b32 s43, 0x00020000
    s_mov_b32 s3, 0xffff0000
    s_lshr_b32 s79, s79, 6
    s_lshl_b32 s74, s66, 11
    s_add_u32 s79, s79, s74
    s_add_u32 s79, s79, 22020096
    s_lshl_b32 s74, s69, 16
    s_add_u32 s75, s74, 2097152
    s_add_u32 s84, s24, s75
    s_addc_u32 s85, s25, 0
    s_mov_b32 s86, 0x10000
    s_mov_b32 s87, 0x00020000
    s_add_u32 s75, s74, 4194304
    s_add_u32 s88, s24, s75
    s_addc_u32 s89, s25, 0
    s_mov_b32 s90, 0x10000
    s_mov_b32 s91, 0x00020000
    s_lshl_b32 s74, s71, 3
    s_add_u32 s74, s74, s64
    s_lshl_b32 s74, s74, 13
    v_lshrrev_b32 v5, 3, v1
    v_lshlrev_b32 v5, 10, v5
    v_and_b32 v6, 7, v1
    s_lshl_b32 s75, s72, 7
    v_lshl_add_u32 v6, v6, 4, s75
    v_add3_u32 v5, v5, v6, s74
    s_mov_b32 s56, s18
    s_mov_b32 s57, s19
    s_mov_b32 s58, 1024
    s_mov_b32 s59, 0x00020000
    s_mov_b32 s60, s20
    s_mov_b32 s61, s21
    s_mov_b32 s62, 0x200000
    s_mov_b32 s63, 0x00020000
    s_mov_b32 s52, s4
    s_mov_b32 s53, s5
    s_mov_b32 s54, 0x200000
    s_mov_b32 s55, 0x00020000
    s_lshl_b32 s74, s72, 7
    s_add_u32 s44, s16, s74
    s_addc_u32 s45, s17, 0
    s_sub_u32 s46, 1835008, s74
    s_mov_b32 s47, 0x00020000
    s_add_u32 s48, s8, s74
    s_addc_u32 s49, s9, 0
    s_sub_u32 s50, 524288, s74
    s_mov_b32 s51, 0x00020000
    v_mul_u32_u24 v16, 1056, v1
    v_add_u32 v16, 66560, v16
    v_mov_b32 v20, 0x3f803f80
    v_mov_b32 v21, v20
    v_mov_b32 v22, v20
    v_mov_b32 v23, v20
    v_mov_b32 v17, 1
    v_mov_b32 v19, 159808
    s_lshr_b32 s74, s69, 1
    s_lshl_b32 s74, s74, 8
    s_add_u32 s74, s74, 20979712
    v_lshl_add_u32 v18, v2, 3, s74
    v_add_u32 v31, 147456, v3
    v_lshrrev_b32 v26, 3, v1
    v_bfe_u32 v27, v1, 4, 1
    v_lshlrev_b32 v27, 2, v27
    v_and_b32 v28, 7, v1
    v_xor_b32 v27, v27, v28
    v_lshlrev_b32 v26, 10, v26
    v_lshl_add_u32 v26, v27, 4, v26
    v_add_u32 v27, 0x2000, v26
    v_bfe_u32 v28, v1, 2, 2
    v_lshl_add_u32 v28, v7, 2, v28
    v_lshlrev_b32 v28, 7, v28
    v_bfe_u32 v29, v1, 3, 1
    v_lshl_add_u32 v28, v29, 6, v28
    v_bfe_u32 v29, v1, 4, 1
    v_lshl_add_u32 v28, v29, 5, v28
    v_and_b32 v29, 3, v1
    v_lshl_add_u32 v28, v29, 3, v28
    v_xor_b32 v29, 64, v28
    s_lshl_b32 s77, s65, 11
    s_add_u32 s77, s77, 135232
    v_add_u32 v28, s77, v28
    v_add_u32 v29, s77, v29
    s_mul_i32 s12, s65, 458752
    s_lshl_b32 s13, s65, 17
    s_mul_i32 s14, s71, 294912
    s_add_u32 s14, s14, 8388608
    s_lshl_b32 s74, s65, 13
    s_add_u32 s15, s14, s74
    s_mul_i32 s74, s65, 28672
    s_add_u32 s14, s14, s74
    s_add_u32 s14, s14, 32768
    s_lshl_b32 s10, s65, 10
    s_mul_i32 s11, s65, 1056
    s_add_u32 s11, s11, 65536
    s_lshl_b32 s74, s70, 2
    s_add_u32 s74, s74, s65
    s_lshl_b32 s74, s74, 11
    s_lshl_b32 s75, s69, 16
    s_add_u32 s78, s74, s75
    v_mov_b64 v[232:233], -1
    v_mov_b64 v[234:235], -1
    s_lshl_b32 s74, s70, 2
    s_add_u32 s74, s74, s65
    s_mul_i32 s6, s74, 294912
    s_lshl_b32 s76, s69, 10
    s_add_u32 s6, s6, s76
    s_add_u32 s6, s6, 8388608
    s_lshl_b32 s74, s74, 5
    s_add_u32 s74, s74, s69
    s_lshl_b32 s74, s74, 3
    s_add_u32 s74, s74, 20996096
    v_mov_b32 v238, s74
    s_lshl_b32 s75, s66, 1
    s_lshr_b32 s76, s65, 1
    s_add_u32 s75, s75, s76
    s_lshl_b32 s75, s75, 3
    s_add_u32 s75, s75, s67
    s_lshl_b32 s75, s75, 1
    s_and_b32 s76, s65, 1
    s_add_u32 s75, s75, s76
    s_lshl_b32 s75, s75, 3
    s_add_u32 s75, s75, 20987904
    s_cmp_eq_u32 s68, 0
    s_cselect_b32 s74, s74, s75
    v_writelane_b32 v238, s74, 1
    s_lshl_b32 s74, s65, 2
    s_add_u32 s74, s74, 159872
    v_mov_b32 v239, s74
    s_add_u32 s74, s10, 32768
    v_add_u32 v240, s74, v3
    s_add_u32 s74, s11, 33792
    v_add_u32 v241, s74, v3
    s_lshl_b32 s74, s71, 7
    s_lshl_b32 s75, s65, 5
    s_add_u32 s74, s74, s75
    s_add_u32 s74, s74, 20987904
    v_and_b32 v24, 3, v1
    v_lshl_add_u32 v242, v24, 3, s74
    s_lshl_b32 s74, s71, 8
    s_lshl_b32 s75, s65, 6
    s_add_u32 s74, s74, s75
    s_add_u32 s74, s74, 20996096
    v_and_b32 v24, 7, v1
    v_lshl_add_u32 v243, v24, 3, s74
    v_lshlrev_b32 v24, 10, v24
    v_bfe_u32 v25, v1, 3, 1
    v_mul_u32_u24 v25, 147456, v25
    v_add_u32 v244, v24, v25
    v_mov_b32 v245, 159908
    v_lshlrev_b32 v248, 10, v1
    v_mul_u32_u24 v249, 147456, v7
    v_lshl_add_u32 v249, v2, 7, v249
    v_mov_b32 v247, 159904
    s_mul_i32 s74, s65, 17408
    v_add_u32 v246, s74, v3
    v_mov_b64 v[32:33], 0
    v_mov_b64 v[34:35], 0
    v_mov_b64 v[36:37], 0
    v_mov_b64 v[38:39], 0
    v_mov_b64 v[40:41], 0
    v_mov_b64 v[42:43], 0
    v_mov_b64 v[44:45], 0
    v_mov_b64 v[46:47], 0
    v_mov_b64 v[48:49], 0
    v_mov_b64 v[50:51], 0
    v_mov_b64 v[52:53], 0
    v_mov_b64 v[54:55], 0
    v_mov_b64 v[56:57], 0
    v_mov_b64 v[58:59], 0
    v_mov_b64 v[60:61], 0
    v_mov_b64 v[62:63], 0
    v_mov_b64 v[64:65], 0
    v_mov_b64 v[66:67], 0
    v_mov_b64 v[68:69], 0
    v_mov_b64 v[70:71], 0
    v_mov_b64 v[72:73], 0
    v_mov_b64 v[74:75], 0
    v_mov_b64 v[76:77], 0
    v_mov_b64 v[78:79], 0
    v_mov_b64 v[80:81], 0
    v_mov_b64 v[82:83], 0
    v_mov_b64 v[84:85], 0
    v_mov_b64 v[86:87], 0
    v_mov_b64 v[88:89], 0
    v_mov_b64 v[90:91], 0
    v_mov_b64 v[92:93], 0
    v_mov_b64 v[94:95], 0
TOUR_h:
    s_cbranch_execz PAD_h_1
    s_cmp_eq_u32 s68, 0
    s_cbranch_scc1 L_h_nst
    v_bfe_u32 v166, v1, 4, 1
    v_cmp_eq_u32 vcc, 1, v166
    v_lshrrev_b32 v166, 4, v1
    v_lshlrev_b32 v166, 3, v166
    s_nop 0
    s_waitcnt vmcnt(0)
    v_cndmask_b32 v169, v230, v231, vcc
    v_add_u32 v169, 1, v169
    v_mov_b32 v171, v169
    s_call_b64 s[100:101], L_dma
    v_lshlrev_b32 v164, 16, v96
    v_and_b32 v165, s3, v96
    v_add_f32 v160, v164, v165
    v_mul_f32 v161, v164, v164
    v_fmac_f32 v161, v165, v165
    v_lshlrev_b32 v164, 16, v97
    v_and_b32 v165, s3, v97
    v_add_f32 v160, v160, v164
    v_fmac_f32 v161, v164, v164
    v_add_f32 v160, v160, v165
    v_fmac_f32 v161, v165, v165
    v_lshlrev_b32 v164, 16, v98
    v_and_b32 v165, s3, v98
    v_add_f32 v160, v160, v164
    v_fmac_f32 v161, v164, v164
    v_add_f32 v160, v160, v165
    v_fmac_f32 v161, v165, v165
    v_lshlrev_b32 v164, 16, v99
    v_and_b32 v165, s3, v99
    v_add_f32 v160, v160, v164
    v_fmac_f32 v161, v164, v164
    v_add_f32 v160, v160, v165
    v_fmac_f32 v161, v165, v165
    v_lshlrev_b32 v164, 16, v100
    v_and_b32 v165, s3, v100
    v_add_f32 v162, v164, v165
    v_mul_f32 v163, v164, v164
    v_fmac_f32 v163, v165, v165
    v_lshlrev_b32 v164, 16, v101
    v_and_b32 v165, s3, v101
    v_add_f32 v162, v162, v164
    v_fmac_f32 v163, v164, v164
    v_add_f32 v162, v162, v165
    v_fmac_f32 v163, v165, v165
    v_lshlrev_b32 v164, 16, v102
    v_and_b32 v165, s3, v102
    v_add_f32 v162, v162, v164
    v_fmac_f32 v163, v164, v164
    v_add_f32 v162, v162, v165
    v_fmac_f32 v163, v165, v165
    v_lshlrev_b32 v164, 16, v103
    v_and_b32 v165, s3, v103
    v_add_f32 v162, v162, v164
    v_fmac_f32 v163, v164, v164
    v_add_f32 v162, v162, v165
    v_fmac_f32 v163, v165, v165
    s_nop 0
    v_permlane32_swap_b32 v160, v162
    v_permlane32_swap_b32 v161, v163
    s_nop 0
    v_add_f32 v160, v160, v162
    v_add_f32 v161, v161, v163
    s_nop 1
    v_permlane16_swap_b32 v160, v161
    s_nop 0
    v_add_f32 v168, v160, v161
    v_lshlrev_b32 v164, 16, v104
    v_and_b32 v165, s3, v104
    v_add_f32 v160, v164, v165
    v_mul_f32 v161, v164, v164
    v_fmac_f32 v161, v165, v165
    v_lshlrev_b32 v164, 16, v105
    v_and_b32 v165, s3, v105
    v_add_f32 v160, v160, v164
    v_fmac_f32 v161, v164, v164
    v_add_f32 v160, v160, v165
    v_fmac_f32 v161, v165, v165
    v_lshlrev_b32 v164, 16, v106
    v_and_b32 v165, s3, v106
    v_add_f32 v160, v160, v164
    v_fmac_f32 v161, v164, v164
    v_add_f32 v160, v160, v165
    v_fmac_f32 v161, v165, v165
    v_lshlrev_b32 v164, 16, v107
    v_and_b32 v165, s3, v107
    v_add_f32 v160, v160, v164
    v_fmac_f32 v161, v164, v164
    v_add_f32 v160, v160, v165
    v_fmac_f32 v161, v165, v165
    v_lshlrev_b32 v164, 16, v108
    v_and_b32 v165, s3, v108
    v_add_f32 v162, v164, v165
    v_mul_f32 v163, v164, v164
    v_fmac_f32 v163, v165, v165
    v_lshlrev_b32 v164, 16, v109
    v_and_b32 v165, s3, v109
    v_add_f32 v162, v162, v164
    v_fmac_f32 v163, v164, v164
    v_add_f32 v162, v162, v165
    v_fmac_f32 v163, v165, v165
    v_lshlrev_b32 v164, 16, v110
    v_and_b32 v165, s3, v110
    v_add_f32 v162, v162, v164
    v_fmac_f32 v163, v164, v164
    v_add_f32 v162, v162, v165
    v_fmac_f32 v163, v165, v165
    v_lshlrev_b32 v164, 16, v111
    v_and_b32 v165, s3, v111
    v_add_f32 v162, v162, v164
    v_fmac_f32 v163, v164, v164
    v_add_f32 v162, v162, v165
    v_fmac_f32 v163, v165, v165
    s_nop 0
    v_permlane32_swap_b32 v160, v162
    v_permlane32_swap_b32 v161, v163
    s_nop 0
    v_add_f32 v160, v160, v162
    v_add_f32 v161, v161, v163
    s_nop 1
    v_permlane16_swap_b32 v160, v161
    s_nop 0
    v_add_f32 v170, v160, v161
    s_nop 0
    v_add_f32_dpp v168, v168, v168 row_ror:8 row_mask:0xf bank_mask:0xf
    v_add_f32_dpp v170, v170, v170 row_ror:8 row_mask:0xf bank_mask:0xf
    s_nop 0
    v_add_f32_dpp v168, v168, v168 row_ror:4 row_mask:0xf bank_mask:0xf
    v_add_f32_dpp v170, v170, v170 row_ror:4 row_mask:0xf bank_mask:0xf
    s_nop 0
    v_add_f32_dpp v168, v168, v168 row_ror:2 row_mask:0xf bank_mask:0xf
    v_add_f32_dpp v170, v170, v170 row_ror:2 row_mask:0xf bank_mask:0xf
    s_nop 0
    v_add_f32_dpp v168, v168, v168 row_ror:1 row_mask:0xf bank_mask:0xf
    v_add_f32_dpp v170, v170, v170 row_ror:1 row_mask:0xf bank_mask:0xf
    s_nop 0
    s_mov_b32 exec_lo, 0x00010001
    s_mov_b32 exec_hi, 0x00010001
    buffer_store_dwordx2 v[168:169], v166, s[28:31], s79 offen sc1
    buffer_store_dwordx2 v[170:171], v166, s[28:31], s79 offen offset:32 sc1
    s_mov_b64 exec, -1
    s_call_b64 s[100:101], L_dma
    s_waitcnt vmcnt(13)
    s_branch L_h_st
L_h_nst:
    s_call_b64 s[100:101], L_dma
    s_waitcnt vmcnt(10)
L_h_st:
    s_mov_b64 exec, -1
    v_add_u32 v230, 1, v230
    v_add_u32 v231, 1, v231
    v_cmp_eq_u32 vcc, 1, v7
    v_readfirstlane_b32 s26, v230
    v_readfirstlane_b32 s27, v231
    v_mov_b64 v[236:237], v[230:231]
    v_cndmask_b32 v230, v230, v231, vcc
    s_waitcnt vmcnt(13)
    s_barrier
    ds_read_b64_tr_b16 v[96:97], v227 offset:0
    ds_read_b64_tr_b16 v[98:99], v227 offset:256
    ds_read_b64_tr_b16 v[100:101], v227 offset:1024
    ds_read_b64_tr_b16 v[102:103], v227 offset:1280
    ds_read_b64_tr_b16 v[104:105], v227 offset:2048
    ds_read_b64_tr_b16 v[106:107], v227 offset:2304
    ds_read_b64_tr_b16 v[108:109], v227 offset:3072
    ds_read_b64_tr_b16 v[110:111], v227 offset:3328
    s_waitcnt lgkmcnt(4)
    ds_read_b64_tr_b16 v[112:113], v227 offset:16384
    ds_read_b64_tr_b16 v[114:115], v227 offset:16640
    ds_read_b64_tr_b16 v[116:117], v227 offset:17408
    ds_read_b64_tr_b16 v[118:119], v227 offset:17664
    ds_read_b64_tr_b16 v[120:121], v227 offset:18432
    ds_read_b64_tr_b16 v[122:123], v227 offset:18688
    ds_read_b64_tr_b16 v[124:125], v227 offset:19456
    ds_read_b64_tr_b16 v[126:127], v227 offset:19712
    s_call_b64 s[100:101], L_dma
    s_waitcnt lgkmcnt(0)
    v_lshlrev_b32 v160, 16, v96
    v_and_b32 v161, s3, v96
    v_lshlrev_b32 v168, 16, v97
    v_and_b32 v169, s3, v97
    v_add_f32 v160, v160, v168
    v_add_f32 v161, v161, v169
    v_lshlrev_b32 v164, 16, v98
    v_and_b32 v165, s3, v98
    v_add_f32 v160, v160, v164
    v_add_f32 v161, v161, v165
    v_lshlrev_b32 v168, 16, v99
    v_and_b32 v169, s3, v99
    v_add_f32 v160, v160, v168
    v_add_f32 v161, v161, v169
    v_lshlrev_b32 v164, 16, v100
    v_and_b32 v165, s3, v100
    v_add_f32 v160, v160, v164
    v_add_f32 v161, v161, v165
    v_lshlrev_b32 v168, 16, v101
    v_and_b32 v169, s3, v101
    v_add_f32 v160, v160, v168
    v_add_f32 v161, v161, v169
    v_lshlrev_b32 v164, 16, v102
    v_and_b32 v165, s3, v102
    v_add_f32 v160, v160, v164
    v_add_f32 v161, v161, v165
    v_lshlrev_b32 v168, 16, v103
    v_and_b32 v169, s3, v103
    v_add_f32 v160, v160, v168
    v_add_f32 v161, v161, v169
    v_lshlrev_b32 v164, 16, v104
    v_and_b32 v165, s3, v104
    v_add_f32 v160, v160, v164
    v_add_f32 v161, v161, v165
    v_lshlrev_b32 v168, 16, v105
    v_and_b32 v169, s3, v105
    v_add_f32 v160, v160, v168
    v_add_f32 v161, v161, v169
    v_lshlrev_b32 v164, 16, v106
    v_and_b32 v165, s3, v106
    v_add_f32 v160, v160, v164
    v_add_f32 v161, v161, v165
    v_lshlrev_b32 v168, 16, v107
    v_and_b32 v169, s3, v107
    v_add_f32 v160, v160, v168
    v_add_f32 v161, v161, v169
    v_lshlrev_b32 v164, 16, v108
    v_and_b32 v165, s3, v108
    v_add_f32 v160, v160, v164
    v_add_f32 v161, v161, v165
    v_lshlrev_b32 v168, 16, v109
    v_and_b32 v169, s3, v109
    v_add_f32 v160, v160, v168
    v_add_f32 v161, v161, v169
    v_lshlrev_b32 v164, 16, v110
    v_and_b32 v165, s3, v110
    v_add_f32 v160, v160, v164
    v_add_f32 v161, v161, v165
    v_lshlrev_b32 v168, 16, v111
    v_and_b32 v169, s3, v111
    v_add_f32 v160, v160, v168
    v_add_f32 v161, v161, v169
    v_add_f32 v160, v160, v161
    s_waitcnt vmcnt(10)
    s_barrier
    s_call_b64 s[100:101], L_dma
    v_lshlrev_b32 v162, 16, v112
    v_and_b32 v163, s3, v112
    v_lshlrev_b32 v168, 16, v113
    v_and_b32 v169, s3, v113
PAD_h_1:
    s_cbranch_execz L_tour_ret
    v_add_f32 v162, v162, v168
    v_add_f32 v163, v163, v169
    v_lshlrev_b32 v164, 16, v114
    v_and_b32 v165, s3, v114
    v_add_f32 v162, v162, v164
    v_add_f32 v163, v163, v165
    v_lshlrev_b32 v168, 16, v115
    v_and_b32 v169, s3, v115
    v_add_f32 v162, v162, v168
    v_add_f32 v163, v163, v169
    v_lshlrev_b32 v164, 16, v116
    v_and_b32 v165, s3, v116
    v_add_f32 v162, v162, v164
    v_add_f32 v163, v163, v165
    v_lshlrev_b32 v168, 16, v117
    v_and_b32 v169, s3, v117
    v_add_f32 v162, v162, v168
    v_add_f32 v163, v163, v169
    v_lshlrev_b32 v164, 16, v118
    v_and_b32 v165, s3, v118
    v_add_f32 v162, v162, v164
    v_add_f32 v163, v163, v165
    v_lshlrev_b32 v168, 16, v119
    v_and_b32 v169, s3, v119
    v_add_f32 v162, v162, v168
    v_add_f32 v163, v163, v169
    v_lshlrev_b32 v164, 16, v120
    v_and_b32 v165, s3, v120
    v_add_f32 v162, v162, v164
    v_add_f32 v163, v163, v165
    v_lshlrev_b32 v168, 16, v121
    v_and_b32 v169, s3, v121
    v_add_f32 v162, v162, v168
    v_add_f32 v163, v163, v169
    v_lshlrev_b32 v164, 16, v122
    v_and_b32 v165, s3, v122
    v_add_f32 v162, v162, v164
    v_add_f32 v163, v163, v165
    v_lshlrev_b32 v168, 16, v123
    v_and_b32 v169, s3, v123
    v_add_f32 v162, v162, v168
    v_add_f32 v163, v163, v169
    v_lshlrev_b32 v164, 16, v124
    v_and_b32 v165, s3, v124
    v_add_f32 v162, v162, v164
    v_add_f32 v163, v163, v165
    v_lshlrev_b32 v168, 16, v125
    v_and_b32 v169, s3, v125
    v_add_f32 v162, v162, v168
    v_add_f32 v163, v163, v169
    v_lshlrev_b32 v164, 16, v126
    v_and_b32 v165, s3, v126
    v_add_f32 v162, v162, v164
    v_add_f32 v163, v163, v165
    v_lshlrev_b32 v168, 16, v127
    v_and_b32 v169, s3, v127
    v_add_f32 v162, v162, v168
    v_add_f32 v163, v163, v169
    v_add_f32 v162, v162, v163
    v_mov_b32 v161, v230
    s_nop 0
    v_permlane32_swap_b32 v160, v162
    s_nop 0
    v_add_f32 v160, v160, v162
    buffer_store_dwordx2 v[160:161], v229, s[28:31], s96 offen sc1
    s_waitcnt vmcnt(11)
    s_barrier
    s_call_b64 s[100:101], L_dma
    s_waitcnt vmcnt(10)
    s_barrier
    s_call_b64 s[100:101], L_dma
    s_mul_i32 s74, s67, 448
    s_lshl_b32 s75, s65, 6
    s_add_u32 s74, s74, s75
    v_lshlrev_b32 v164, 1, v2
    v_lshl_add_u32 v164, v7, 8, v164
    buffer_load_ushort v156, v164, s[40:43], s74 offen
    s_waitcnt vmcnt(11)
    s_barrier
    s_call_b64 s[100:101], L_dma
    s_waitcnt vmcnt(10)
    s_barrier
    s_call_b64 s[100:101], L_dma
    buffer_load_dwordx2 v[136:137], v229, s[28:31], 0 offen offset:0 sc1
    buffer_load_dwordx2 v[138:139], v229, s[28:31], 0 offen offset:512 sc1
    buffer_load_dwordx2 v[140:141], v229, s[28:31], 0 offen offset:1024 sc1
    buffer_load_dwordx2 v[142:143], v229, s[28:31], 0 offen offset:1536 sc1
    s_waitcnt vmcnt(14)
    s_barrier
    buffer_load_dwordx2 v[144:145], v229, s[28:31], 0 offen offset:2048 sc1
    buffer_load_dwordx2 v[146:147], v229, s[28:31], 0 offen offset:2560 sc1
    buffer_load_dwordx2 v[148:149], v229, s[28:31], 0 offen offset:3072 sc1
    buffer_load_dwordx2 v[150:151], v229, s[28:31], 0 offen offset:3584 sc1
    buffer_load_dwordx4 v[152:155], v228, s[28:31], 0 offen sc1
    s_waitcnt vmcnt(9)
    s_barrier
    s_waitcnt vmcnt(0)
    s_mov_b32 s79, 0x4000
L_h_chk:
    v_xor_b32 v153, s26, v153
    v_xor_b32 v155, s27, v155
    v_or_b32 v164, v153, v155
    v_xor_b32 v137, v230, v137
    v_xor_b32 v139, v230, v139
    v_xor_b32 v141, v230, v141
    v_xor_b32 v143, v230, v143
    v_xor_b32 v145, v230, v145
    v_xor_b32 v147, v230, v147
    v_xor_b32 v149, v230, v149
    v_xor_b32 v151, v230, v151
    v_or3_b32 v164, v164, v137, v139
    v_or3_b32 v164, v164, v141, v143
    v_or3_b32 v164, v164, v145, v147
    v_or3_b32 v164, v164, v149, v151
    v_cmp_ne_u32 vcc, 0, v164
    s_sub_u32 s79, s79, 1
    s_cmp_eq_u32 s79, 0
    s_cbranch_scc1 L_h_got
    s_cbranch_vccz L_h_got
    buffer_load_dwordx2 v[136:137], v229, s[28:31], 0 offen offset:0 sc1
    buffer_load_dwordx2 v[138:139], v229, s[28:31], 0 offen offset:512 sc1
    buffer_load_dwordx2 v[140:141], v229, s[28:31], 0 offen offset:1024 sc1
    buffer_load_dwordx2 v[142:143], v229, s[28:31], 0 offen offset:1536 sc1
    buffer_load_dwordx2 v[144:145], v229, s[28:31], 0 offen offset:2048 sc1
    buffer_load_dwordx2 v[146:147], v229, s[28:31], 0 offen offset:2560 sc1
    buffer_load_dwordx2 v[148:149], v229, s[28:31], 0 offen offset:3072 sc1
    buffer_load_dwordx2 v[150:151], v229, s[28:31], 0 offen offset:3584 sc1
    buffer_load_dwordx4 v[152:155], v228, s[28:31], 0 offen sc1
    s_waitcnt vmcnt(0)
    s_branch L_h_chk
L_h_got:
    s_mov_b32 s74, 0x3b000000
    v_mul_f32 v96, s74, v152
    v_mul_f32 v97, s74, v154
    v_add_f32 v136, v136, v138
    v_fma_f32 v97, -v96, v96, v97
    v_add_f32 v140, v140, v142
    v_max_f32 v97, 0, v97
    v_add_f32 v144, v144, v146
    v_cvt_pk_bf16_f32 v97, v97, v97
    v_add_f32 v148, v148, v150
    v_and_b32 v97, s3, v97
    v_add_f32 v136, v136, v140
    v_add_f32 v97, 0x3727c5ac, v97
    v_add_f32 v144, v144, v148
    v_cvt_pk_bf16_f32 v97, v97, v97
    v_add_f32 v136, v136, v144
    v_and_b32 v97, s3, v97
    v_sqrt_f32 v97, v97
    v_mul_f32 v96, -0.5, v96
    v_and_b32 v137, s3, v136
    v_cvt_pk_bf16_f32 v97, v97, v97
    v_sub_f32 v136, v136, v137
    v_and_b32 v97, s3, v97
    v_and_b32 v138, s3, v136
    v_rcp_f32 v98, v97
    v_mul_f32 v99, 0.5, v97
    v_sub_f32 v136, v136, v138
    v_cvt_pk_bf16_f32 v100, v96, v96
    v_cvt_pk_bf16_f32 v101, v96, v99
    v_cvt_pk_bf16_f32 v140, v137, v138
    v_lshlrev_b32 v156, 16, v156
    v_cvt_pk_bf16_f32 v141, v136, v156
    s_lshl_b32 s74, s65, 8
    v_lshl_add_u32 v102, v2, 3, s74
    v_lshrrev_b32 v103, 1, v102
    v_add_u32 v102, 159936, v102
    v_add_u32 v103, 160960, v103
    v_lshl_add_u32 v104, v7, 10, v102
    ds_write_b64 v102, v[100:101]
    ds_write_b32 v103, v98
    ds_write_b32 v103, v97 offset:512
    ds_write_b64 v104, v[140:141] offset:2048
    s_waitcnt lgkmcnt(0)
    s_waitcnt vmcnt(0)
    s_barrier
L_f:
TOUR_f:
    s_cbranch_execz PAD_f_1
    ds_write_b128 v16, v[20:23]
    ds_write_b128 v16, v[32:35] offset:16
    s_add_u32 m0, s77, 8192
    s_nop 0
    buffer_load_dwordx4 v26, s[48:51], s13 offen lds
    s_add_u32 m0, s77, 9216
    s_nop 0
    buffer_load_dwordx4 v27, s[48:51], s13 offen lds
    s_add_u32 s13, s13, 16384
    s_add_u32 m0, s77, 16384
    s_nop 0
    buffer_load_dwordx4 v26, s[48:51], s13 offen lds
    s_add_u32 m0, s77, 17408
    s_nop 0
    buffer_load_dwordx4 v27, s[48:51], s13 offen lds
    s_add_u32 s13, s13, 16384
    s_cmp_eq_u32 s65, 0
    s_cselect_b32 s75, 4, 5
L_f_hw:
    ds_read_b32 v24, v247
    s_waitcnt lgkmcnt(0)
    v_readfirstlane_b32 s74, v24
    s_cmp_eq_u32 s74, s75
    s_cbranch_scc1 L_f_hw_done
    s_sleep 1
    s_branch L_f_hw
L_f_hw_done:
    s_nop 0
    s_cmp_lg_u32 s65, 0
    s_cbranch_scc1 L_f_go
    s_mov_b32 s79, 0x8000
L_f_p2:
    buffer_load_dwordx2 v[24:25], v18, s[28:31], 0 offen sc1
    s_sub_u32 s79, s79, 1
    s_waitcnt vmcnt(0)
    v_cmp_ne_u64 vcc, s[26:27], v[24:25]
    s_cmp_eq_u32 s79, 0
    s_cbranch_scc1 L_f_p2_done
    s_cbranch_vccz L_f_p2_done
    s_sleep 4
    s_branch L_f_p2
L_f_p2_done:
    s_mov_b64 exec, 1
    ds_add_u32 v247, v17
    s_mov_b64 exec, -1
L_f_go:
    s_mov_b32 m0, s77
    s_nop 0
    buffer_load_dwordx4 v3, s[28:31], s78 offen sc1 lds
    buffer_load_dwordx4 v3, s[28:31], s78 offen offset:1024 sc1 lds
    s_mov_b32 m0, s10
    s_add_u32 s74, s11, 0
    buffer_load_dwordx4 v3, s[84:87], s10 offen sc1 lds
    s_mov_b32 m0, s74
    s_nop 0
    buffer_load_dwordx4 v3, s[88:91], s10 offen sc1 lds
    s_add_u32 s10, s10, 4096
    s_mov_b32 m0, s10
    s_add_u32 s74, s11, 4224
    buffer_load_dwordx4 v3, s[84:87], s10 offen sc1 lds
    s_mov_b32 m0, s74
    s_nop 0
    buffer_load_dwordx4 v3, s[88:91], s10 offen sc1 lds
    s_add_u32 s10, s10, 4096
    s_mov_b32 m0, s10
    s_add_u32 s74, s11, 8448
    buffer_load_dwordx4 v3, s[84:87], s10 offen sc1 lds
    s_mov_b32 m0, s74
    s_nop 0
    buffer_load_dwordx4 v3, s[88:91], s10 offen sc1 lds
    s_add_u32 s10, s10, 4096
    s_mov_b32 m0, s10
    s_add_u32 s74, s11, 12672
    buffer_load_dwordx4 v3, s[84:87], s10 offen sc1 lds
    s_mov_b32 m0, s74
    s_nop 0
    buffer_load_dwordx4 v3, s[88:91], s10 offen sc1 lds
    s_add_u32 s10, s10, 4096
    s_mov_b32 m0, s10
    s_add_u32 s74, s11, 16896
    buffer_load_dwordx4 v3, s[84:87], s10 offen sc1 lds
    s_mov_b32 m0, s74
    s_nop 0
    buffer_load_dwordx4 v3, s[88:91], s10 offen sc1 lds
    s_add_u32 s10, s10, 4096
    s_mov_b32 m0, s10
    s_add_u32 s74, s11, 21120
    buffer_load_dwordx4 v3, s[84:87], s10 offen sc1 lds
    s_mov_b32 m0, s74
    s_nop 0
    buffer_load_dwordx4 v3, s[88:91], s10 offen sc1 lds
    s_add_u32 s10, s10, 4096
    s_waitcnt vmcnt(8)
    s_mov_b64 exec, 1
    ds_add_u32 v19, v17 offset:0
    s_mov_b64 exec, -1
    s_mov_b32 m0, s10
    s_add_u32 s74, s11, 25344
    buffer_load_dwordx4 v3, s[84:87], s10 offen sc1 lds
    s_mov_b32 m0, s74
    s_nop 0
    buffer_load_dwordx4 v3, s[88:91], s10 offen sc1 lds
    s_add_u32 s10, s10, 4096
    s_mov_b32 m0, s10
    s_add_u32 s74, s11, 29568
    buffer_load_dwordx4 v3, s[84:87], s10 offen sc1 lds
    s_mov_b32 m0, s74
    s_nop 0
    buffer_load_dwordx4 v3, s[88:91], s10 offen sc1 lds
    s_add_u32 s10, s10, 4096
    s_waitcnt vmcnt(8)
    s_mov_b64 exec, 1
    ds_add_u32 v19, v17 offset:4
    s_mov_b64 exec, -1
    s_waitcnt vmcnt(4)
    s_mov_b64 exec, 1
    ds_add_u32 v19, v17 offset:8
    s_mov_b64 exec, -1
    s_waitcnt vmcnt(0)
    s_mov_b64 exec, 1
    ds_add_u32 v19, v17 offset:12
    s_mov_b64 exec, -1
    buffer_store_dwordx4 v[232:235], v3, s[28:31], s6 offen sc1
    buffer_store_dwordx4 v[232:235], v31, s[28:31], s6 offen sc1
L_f_qw:
    ds_read_b32 v24, v239
    s_waitcnt lgkmcnt(0)
    v_readfirstlane_b32 s74, v24
    s_cmp_eq_u32 s74, 1
    s_cbranch_scc1 L_f_qw_done
    s_sleep 2
    s_branch L_f_qw
L_f_qw_done:
    ds_read_b128 v[96:99], v240 offset:0
    ds_read_b128 v[100:103], v240 offset:4096
    ds_read_b128 v[104:107], v240 offset:8192
    ds_read_b128 v[108:111], v240 offset:12288
    ds_read_b128 v[112:115], v240 offset:16384
    ds_read_b128 v[116:119], v240 offset:20480
    ds_read_b128 v[120:123], v240 offset:24576
    ds_read_b128 v[124:127], v240 offset:28672
    ds_read_b128 v[128:131], v241 offset:0
    ds_read_b128 v[132:135], v241 offset:4224
    ds_read_b128 v[136:139], v241 offset:8448
    ds_read_b128 v[140:143], v241 offset:12672
    ds_read_b128 v[144:147], v241 offset:16896
    ds_read_b128 v[148:151], v241 offset:21120
    s_waitcnt lgkmcnt(0)
    s_mov_b32 m0, s10
    s_add_u32 s74, s11, 33792
    buffer_load_dwordx4 v3, s[84:87], s10 offen sc1 lds
    s_mov_b32 m0, s74
    s_nop 0
    buffer_load_dwordx4 v3, s[88:91], s10 offen sc1 lds
    s_add_u32 s10, s10, 4096
    s_mov_b32 m0, s10
    s_add_u32 s74, s11, 38016
    buffer_load_dwordx4 v3, s[84:87], s10 offen sc1 lds
    s_mov_b32 m0, s74
    s_nop 0
    buffer_load_dwordx4 v3, s[88:91], s10 offen sc1 lds
    s_add_u32 s10, s10, 4096
    s_mov_b32 m0, s10
    s_add_u32 s74, s11, 42240
    buffer_load_dwordx4 v3, s[84:87], s10 offen sc1 lds
    s_mov_b32 m0, s74
    s_nop 0
    buffer_load_dwordx4 v3, s[88:91], s10 offen sc1 lds
    s_add_u32 s10, s10, 4096
    s_mov_b32 m0, s10
    s_add_u32 s74, s11, 46464
    buffer_load_dwordx4 v3, s[84:87], s10 offen sc1 lds
    s_mov_b32 m0, s74
    s_nop 0
    buffer_load_dwordx4 v3, s[88:91], s10 offen sc1 lds
    s_add_u32 s10, s10, 4096
    s_mov_b32 m0, s10
    s_add_u32 s74, s11, 50688
    buffer_load_dwordx4 v3, s[84:87], s10 offen sc1 lds
    s_mov_b32 m0, s74
    s_nop 0
    buffer_load_dwordx4 v3, s[88:91], s10 offen sc1 lds
    s_add_u32 s10, s10, 4096
    s_mov_b32 m0, s10
    s_add_u32 s74, s11, 54912
    buffer_load_dwordx4 v3, s[84:87], s10 offen sc1 lds
    s_mov_b32 m0, s74
    s_nop 0
    buffer_load_dwordx4 v3, s[88:91], s10 offen sc1 lds
PAD_f_1:
    s_cbranch_execz PAD_f_2
    s_add_u32 s10, s10, 4096
    s_mov_b32 m0, s10
    s_add_u32 s74, s11, 59136
    buffer_load_dwordx4 v3, s[84:87], s10 offen sc1 lds
    s_mov_b32 m0, s74
    s_nop 0
    buffer_load_dwordx4 v3, s[88:91], s10 offen sc1 lds
    s_add_u32 s10, s10, 4096
    s_mov_b32 m0, s10
    s_add_u32 s74, s11, 63360
    buffer_load_dwordx4 v3, s[84:87], s10 offen sc1 lds
    s_mov_b32 m0, s74
    s_nop 0
    buffer_load_dwordx4 v3, s[88:91], s10 offen sc1 lds
    s_add_u32 s10, s10, 4096
    s_cmp_eq_u32 s68, 0
    s_cbranch_scc1 L_f_noh
    s_lshl_b32 s74, s66, 2
    s_add_u32 s74, s74, s65
    s_xor_b32 s75, s74, 1
    s_mul_i32 s76, s67, 14336
    s_add_u32 s76, s76, 8421376
    s_mul_i32 s92, s74, 147456
    s_add_u32 s92, s92, s76
    s_mul_i32 s93, s75, 147456
    s_add_u32 s93, s93, s76
    s_add_u32 s94, s92, 12288
    s_and_b32 s75, s65, 1
    s_mul_i32 s76, s75, 6144
    s_add_u32 s92, s92, s76
    s_add_u32 s93, s93, s76
    s_add_u32 s95, s92, 4096
    s_add_u32 s96, s93, 4096
    buffer_store_dwordx4 v[96:99], v3, s[28:31], s92 offen offset:0 sc1
    buffer_store_dwordx4 v[100:103], v3, s[28:31], s92 offen offset:1024 sc1
    buffer_store_dwordx4 v[104:107], v3, s[28:31], s93 offen offset:0 sc1
    buffer_store_dwordx4 v[108:111], v3, s[28:31], s93 offen offset:1024 sc1
    buffer_store_dwordx4 v[112:115], v3, s[28:31], s92 offen offset:2048 sc1
    buffer_store_dwordx4 v[116:119], v3, s[28:31], s92 offen offset:3072 sc1
    buffer_store_dwordx4 v[120:123], v3, s[28:31], s93 offen offset:2048 sc1
    buffer_store_dwordx4 v[124:127], v3, s[28:31], s93 offen offset:3072 sc1
    buffer_store_dwordx4 v[128:131], v3, s[28:31], s95 offen offset:0 sc1
    buffer_store_dwordx4 v[132:135], v3, s[28:31], s95 offen offset:1024 sc1
    buffer_store_dwordx4 v[136:139], v3, s[28:31], s96 offen offset:0 sc1
    buffer_store_dwordx4 v[140:143], v3, s[28:31], s96 offen offset:1024 sc1
    buffer_store_dwordx4 v[144:147], v3, s[28:31], s94 offen offset:0 sc1
    buffer_store_dwordx4 v[148:151], v3, s[28:31], s94 offen offset:1024 sc1
L_f_noh:
    s_mov_b32 s40, s22
    s_mov_b32 s41, s23
    s_mov_b32 s42, 256
    s_waitcnt vmcnt(0)
    s_mov_b64 exec, 3
    buffer_store_dwordx2 v[236:237], v238, s[28:31], 0 offen sc1
    s_mov_b64 exec, 1
    ds_add_u32 v19, v17 offset:16
    ds_add_u32 v19, v17 offset:20
    ds_add_u32 v19, v17 offset:24
    ds_add_u32 v19, v17 offset:28
    s_cmp_lg_u32 s65, 0
    s_cbranch_scc1 L_f_noat
    buffer_atomic_add v17, v4, s[40:43], 0 offen sc1
L_f_noat:
    s_mov_b64 exec, -1
    s_and_b32 s74, s71, 3
    s_mul_i32 s74, s74, 114688
    s_add_u32 s74, s74, s12
    s_add_u32 s75, s74, 49152
    buffer_load_dword v253, v248, s[44:47], s74 offen
    buffer_load_dword v253, v248, s[44:47], s75 offen
    s_add_u32 m0, s77, 0
    s_nop 0
    buffer_load_dwordx4 v26, s[48:51], s13 offen lds
    s_add_u32 m0, s77, 1024
    s_nop 0
    buffer_load_dwordx4 v27, s[48:51], s13 offen lds
    s_add_u32 s13, s13, 16384
    ds_read_b64_tr_b16 v[160:161], v28 offset:8192
    ds_read_b64_tr_b16 v[162:163], v28 offset:9216
    ds_read_b64_tr_b16 v[164:165], v29 offset:8192
    ds_read_b64_tr_b16 v[166:167], v29 offset:9216
    s_waitcnt lgkmcnt(0)
    s_add_u32 m0, s77, 8192
    s_nop 0
    buffer_load_dwordx4 v26, s[48:51], s13 offen lds
    s_add_u32 m0, s77, 9216
    s_nop 0
    buffer_load_dwordx4 v27, s[48:51], s13 offen lds
    s_add_u32 s13, s13, 16384
    ds_read_b64_tr_b16 v[168:169], v28 offset:16384
    ds_read_b64_tr_b16 v[170:171], v28 offset:17408
    ds_read_b64_tr_b16 v[172:173], v29 offset:16384
    ds_read_b64_tr_b16 v[174:175], v29 offset:17408
    s_waitcnt lgkmcnt(0)
    s_add_u32 m0, s77, 16384
    s_nop 0
    buffer_load_dwordx4 v26, s[48:51], s13 offen lds
    s_add_u32 m0, s77, 17408
    s_nop 0
    buffer_load_dwordx4 v27, s[48:51], s13 offen lds
    s_add_u32 s13, s13, 16384
    s_waitcnt vmcnt(4)
    ds_read_b64_tr_b16 v[176:177], v28 offset:0
    ds_read_b64_tr_b16 v[178:179], v28 offset:1024
    ds_read_b64_tr_b16 v[180:181], v29 offset:0
    ds_read_b64_tr_b16 v[182:183], v29 offset:1024
    s_waitcnt lgkmcnt(0)
    s_add_u32 m0, s77, 0
    s_nop 0
    buffer_load_dwordx4 v26, s[48:51], s13 offen lds
    s_add_u32 m0, s77, 1024
    s_nop 0
    buffer_load_dwordx4 v27, s[48:51], s13 offen lds
    s_add_u32 s13, s13, 16384
    s_waitcnt vmcnt(4)
    ds_read_b64_tr_b16 v[184:185], v28 offset:8192
    ds_read_b64_tr_b16 v[186:187], v28 offset:9216
    ds_read_b64_tr_b16 v[188:189], v29 offset:8192
    ds_read_b64_tr_b16 v[190:191], v29 offset:9216
    s_waitcnt lgkmcnt(0)
    s_add_u32 m0, s77, 8192
    s_nop 0
    buffer_load_dwordx4 v26, s[48:51], s13 offen lds
    s_add_u32 m0, s77, 9216
    s_nop 0
    buffer_load_dwordx4 v27, s[48:51], s13 offen lds
    s_add_u32 s13, s13, 16384
    s_waitcnt vmcnt(4)
    ds_read_b64_tr_b16 v[192:193], v28 offset:16384
    ds_read_b64_tr_b16 v[194:195], v28 offset:17408
    ds_read_b64_tr_b16 v[196:197], v29 offset:16384
    ds_read_b64_tr_b16 v[198:199], v29 offset:17408
    s_waitcnt lgkmcnt(0)
    s_add_u32 m0, s77, 16384
    s_nop 0
    buffer_load_dwordx4 v26, s[48:51], s13 offen lds
    s_add_u32 m0, s77, 17408
    s_nop 0
    buffer_load_dwordx4 v27, s[48:51], s13 offen lds
    s_add_u32 s13, s13, 16384
    s_waitcnt vmcnt(4)
    ds_read_b64_tr_b16 v[200:201], v28 offset:0
    ds_read_b64_tr_b16 v[202:203], v28 offset:1024
    ds_read_b64_tr_b16 v[204:205], v29 offset:0
    ds_read_b64_tr_b16 v[206:207], v29 offset:1024
    s_waitcnt lgkmcnt(0)
    s_waitcnt vmcnt(2)
    ds_read_b64_tr_b16 v[208:209], v28 offset:8192
    ds_read_b64_tr_b16 v[210:211], v28 offset:9216
    ds_read_b64_tr_b16 v[212:213], v29 offset:8192
    ds_read_b64_tr_b16 v[214:215], v29 offset:9216
    s_waitcnt lgkmcnt(0)
    s_add_u32 m0, s77, 8192
    s_nop 0
    buffer_load_dwordx4 v26, s[44:47], s12 offen lds
    s_add_u32 m0, s77, 9216
    s_nop 0
    buffer_load_dwordx4 v27, s[44:47], s12 offen lds
    s_add_u32 s12, s12, 16384
    s_waitcnt vmcnt(2)
    ds_read_b64_tr_b16 v[216:217], v28 offset:16384
    ds_read_b64_tr_b16 v[218:219], v28 offset:17408
    ds_read_b64_tr_b16 v[220:221], v29 offset:16384
    ds_read_b64_tr_b16 v[222:223], v29 offset:17408
    s_waitcnt lgkmcnt(0)
    s_add_u32 m0, s77, 16384
    s_nop 0
    buffer_load_dwordx4 v26, s[44:47], s12 offen lds
PAD_f_2:
    s_cbranch_execz PAD_f_3
    s_add_u32 m0, s77, 17408
    s_nop 0
    buffer_load_dwordx4 v27, s[44:47], s12 offen lds
    s_add_u32 s12, s12, 16384
    s_add_u32 m0, s77, 0
    s_nop 0
    buffer_load_dwordx4 v26, s[44:47], s12 offen lds
    s_add_u32 m0, s77, 1024
    s_nop 0
    buffer_load_dwordx4 v27, s[44:47], s12 offen lds
    s_add_u32 s12, s12, 16384
    s_mov_b32 s79, 0x8000
L_f_p3:
    buffer_load_dwordx2 v[24:25], v242, s[28:31], 0 offen sc1
    s_sub_u32 s79, s79, 1
    s_waitcnt vmcnt(0)
    v_cmp_ne_u64 vcc, s[26:27], v[24:25]
    s_cmp_eq_u32 s79, 0
    s_cbranch_scc1 L_f_p3_done
    s_cbranch_vccz L_f_p3_done
    s_sleep 8
    s_branch L_f_p3
L_f_p3_done:
    s_setprio 0
    s_mul_i32 s74, s72, 3584
    s_add_u32 s74, s74, s14
    s_mov_b32 exec_lo, 0x0fffffff
    s_mov_b32 exec_hi, 0x0fffffff
    buffer_load_dword v253, v249, s[28:31], s74 offen sc1
    s_mov_b64 exec, -1
    buffer_load_dwordx4 v[96:99], v3, s[28:31], s14 offen sc1
    buffer_load_dwordx4 v[100:103], v31, s[28:31], s14 offen sc1
    s_add_u32 s14, s14, 1024
    buffer_load_dwordx4 v[104:107], v3, s[28:31], s14 offen sc1
    buffer_load_dwordx4 v[108:111], v31, s[28:31], s14 offen sc1
    s_add_u32 s14, s14, 1024
    buffer_load_dwordx4 v[112:115], v3, s[28:31], s14 offen sc1
    buffer_load_dwordx4 v[116:119], v31, s[28:31], s14 offen sc1
    s_add_u32 s14, s14, 1024
    s_waitcnt vmcnt(0)
    s_mov_b32 s79, 8
L_f_loop:
    s_waitcnt vmcnt(8)
    ds_read_b64_tr_b16 v[120:121], v28 offset:8192
    ds_read_b64_tr_b16 v[122:123], v28 offset:9216
    s_waitcnt lgkmcnt(0)
    v_mfma_f32_32x32x16_bf16 v[32:47], v[120:123], v[96:99], v[32:47]
    ds_read_b64_tr_b16 v[124:125], v29 offset:8192
    ds_read_b64_tr_b16 v[126:127], v29 offset:9216
    s_waitcnt lgkmcnt(0)
    v_mfma_f32_32x32x16_bf16 v[64:79], v[124:127], v[96:99], v[64:79]
    buffer_load_dwordx4 v[96:99], v3, s[28:31], s14 offen sc1
    ds_read_b64_tr_b16 v[120:121], v28 offset:8192
    ds_read_b64_tr_b16 v[122:123], v28 offset:9216
    s_waitcnt lgkmcnt(0)
    v_mfma_f32_32x32x16_bf16 v[48:63], v[120:123], v[100:103], v[48:63]
    s_add_u32 m0, s77, 8192
    s_nop 0
    buffer_load_dwordx4 v26, s[44:47], s12 offen lds
    s_add_u32 m0, s77, 9216
    s_nop 0
    buffer_load_dwordx4 v27, s[44:47], s12 offen lds
    s_add_u32 s12, s12, 16384
    v_mfma_f32_32x32x16_bf16 v[80:95], v[124:127], v[100:103], v[80:95]
    buffer_load_dwordx4 v[100:103], v31, s[28:31], s14 offen sc1
    s_add_u32 s14, s14, 1024
    s_waitcnt vmcnt(8)
    ds_read_b64_tr_b16 v[120:121], v28 offset:16384
    ds_read_b64_tr_b16 v[122:123], v28 offset:17408
    s_waitcnt lgkmcnt(0)
    v_mfma_f32_32x32x16_bf16 v[32:47], v[120:123], v[104:107], v[32:47]
    ds_read_b64_tr_b16 v[124:125], v29 offset:16384
    ds_read_b64_tr_b16 v[126:127], v29 offset:17408
    s_waitcnt lgkmcnt(0)
    v_mfma_f32_32x32x16_bf16 v[64:79], v[124:127], v[104:107], v[64:79]
    buffer_load_dwordx4 v[104:107], v3, s[28:31], s14 offen sc1
    ds_read_b64_tr_b16 v[120:121], v28 offset:16384
    ds_read_b64_tr_b16 v[122:123], v28 offset:17408
    s_waitcnt lgkmcnt(0)
    v_mfma_f32_32x32x16_bf16 v[48:63], v[120:123], v[108:111], v[48:63]
    s_add_u32 m0, s77, 16384
    s_nop 0
    buffer_load_dwordx4 v26, s[44:47], s12 offen lds
    s_add_u32 m0, s77, 17408
    s_nop 0
    buffer_load_dwordx4 v27, s[44:47], s12 offen lds
    s_add_u32 s12, s12, 16384
    v_mfma_f32_32x32x16_bf16 v[80:95], v[124:127], v[108:111], v[80:95]
    buffer_load_dwordx4 v[108:111], v31, s[28:31], s14 offen sc1
    s_add_u32 s14, s14, 1024
    s_waitcnt vmcnt(8)
    ds_read_b64_tr_b16 v[120:121], v28 offset:0
    ds_read_b64_tr_b16 v[122:123], v28 offset:1024
    s_waitcnt lgkmcnt(0)
    v_mfma_f32_32x32x16_bf16 v[32:47], v[120:123], v[112:115], v[32:47]
    ds_read_b64_tr_b16 v[124:125], v29 offset:0
    ds_read_b64_tr_b16 v[126:127], v29 offset:1024
    s_waitcnt lgkmcnt(0)
    v_mfma_f32_32x32x16_bf16 v[64:79], v[124:127], v[112:115], v[64:79]
    buffer_load_dwordx4 v[112:115], v3, s[28:31], s14 offen sc1
    ds_read_b64_tr_b16 v[120:121], v28 offset:0
    ds_read_b64_tr_b16 v[122:123], v28 offset:1024
    s_waitcnt lgkmcnt(0)
    v_mfma_f32_32x32x16_bf16 v[48:63], v[120:123], v[116:119], v[48:63]
    s_add_u32 m0, s77, 0
    s_nop 0
    buffer_load_dwordx4 v26, s[44:47], s12 offen lds
    s_add_u32 m0, s77, 1024
    s_nop 0
    buffer_load_dwordx4 v27, s[44:47], s12 offen lds
    s_add_u32 s12, s12, 16384
    v_mfma_f32_32x32x16_bf16 v[80:95], v[124:127], v[116:119], v[80:95]
    buffer_load_dwordx4 v[116:119], v31, s[28:31], s14 offen sc1
    s_add_u32 s14, s14, 1024
    s_sub_u32 s79, s79, 1
    s_cmp_lg_u32 s79, 0
    s_cbranch_scc1 L_f_loop
    s_waitcnt vmcnt(8)
    ds_read_b64_tr_b16 v[120:121], v28 offset:8192
    ds_read_b64_tr_b16 v[122:123], v28 offset:9216
    s_waitcnt lgkmcnt(0)
    v_mfma_f32_32x32x16_bf16 v[32:47], v[120:123], v[96:99], v[32:47]
    ds_read_b64_tr_b16 v[124:125], v29 offset:8192
    ds_read_b64_tr_b16 v[126:127], v29 offset:9216
    s_waitcnt lgkmcnt(0)
    v_mfma_f32_32x32x16_bf16 v[64:79], v[124:127], v[96:99], v[64:79]
    buffer_load_dwordx4 v[96:99], v3, s[28:31], s14 offen sc1
    ds_read_b64_tr_b16 v[120:121], v28 offset:8192
    ds_read_b64_tr_b16 v[122:123], v28 offset:9216
    s_waitcnt lgkmcnt(0)
    v_mfma_f32_32x32x16_bf16 v[48:63], v[120:123], v[100:103], v[48:63]
    s_add_u32 m0, s77, 8192
    s_nop 0
    buffer_load_dwordx4 v26, s[44:47], s12 offen lds
    s_add_u32 m0, s77, 9216
    s_nop 0
    buffer_load_dwordx4 v27, s[44:47], s12 offen lds
    s_add_u32 s12, s12, 16384
    v_mfma_f32_32x32x16_bf16 v[80:95], v[124:127], v[100:103], v[80:95]
    buffer_load_dwordx4 v[100:103], v31, s[28:31], s14 offen sc1
    s_add_u32 s14, s14, 1024
    s_waitcnt vmcnt(8)
    ds_read_b64_tr_b16 v[120:121], v28 offset:16384
    ds_read_b64_tr_b16 v[122:123], v28 offset:17408
    s_waitcnt lgkmcnt(0)
    v_mfma_f32_32x32x16_bf16 v[32:47], v[120:123], v[104:107], v[32:47]
    ds_read_b64_tr_b16 v[124:125], v29 offset:16384
    ds_read_b64_tr_b16 v[126:127], v29 offset:17408
    s_waitcnt lgkmcnt(0)
    v_mfma_f32_32x32x16_bf16 v[64:79], v[124:127], v[104:107], v[64:79]
    ds_read_b64_tr_b16 v[120:121], v28 offset:16384
    ds_read_b64_tr_b16 v[122:123], v28 offset:17408
    s_waitcnt lgkmcnt(0)
    v_mfma_f32_32x32x16_bf16 v[48:63], v[120:123], v[108:111], v[48:63]
    ds_read_b64_tr_b16 v[124:125], v29 offset:16384
    ds_read_b64_tr_b16 v[126:127], v29 offset:17408
    s_waitcnt lgkmcnt(0)
    v_mfma_f32_32x32x16_bf16 v[80:95], v[124:127], v[108:111], v[80:95]
    s_waitcnt vmcnt(4)
    ds_read_b64_tr_b16 v[120:121], v28 offset:0
    ds_read_b64_tr_b16 v[122:123], v28 offset:1024
    s_waitcnt lgkmcnt(0)
    v_mfma_f32_32x32x16_bf16 v[32:47], v[120:123], v[112:115], v[32:47]
    ds_read_b64_tr_b16 v[124:125], v29 offset:0
    ds_read_b64_tr_b16 v[126:127], v29 offset:1024
    s_waitcnt lgkmcnt(0)
    v_mfma_f32_32x32x16_bf16 v[64:79], v[124:127], v[112:115], v[64:79]
    ds_read_b64_tr_b16 v[120:121], v28 offset:0
    ds_read_b64_tr_b16 v[122:123], v28 offset:1024
    s_waitcnt lgkmcnt(0)
    v_mfma_f32_32x32x16_bf16 v[48:63], v[120:123], v[116:119], v[48:63]
    ds_read_b64_tr_b16 v[124:125], v29 offset:0
    ds_read_b64_tr_b16 v[126:127], v29 offset:1024
    s_waitcnt lgkmcnt(0)
    v_mfma_f32_32x32x16_bf16 v[80:95], v[124:127], v[116:119], v[80:95]
    s_waitcnt vmcnt(0)
    ds_read_b64_tr_b16 v[120:121], v28 offset:8192
    ds_read_b64_tr_b16 v[122:123], v28 offset:9216
    s_waitcnt lgkmcnt(0)
    v_mfma_f32_32x32x16_bf16 v[32:47], v[120:123], v[96:99], v[32:47]
    ds_read_b64_tr_b16 v[124:125], v29 offset:8192
    ds_read_b64_tr_b16 v[126:127], v29 offset:9216
    s_waitcnt lgkmcnt(0)
    v_mfma_f32_32x32x16_bf16 v[64:79], v[124:127], v[96:99], v[64:79]
    ds_read_b64_tr_b16 v[120:121], v28 offset:8192
    ds_read_b64_tr_b16 v[122:123], v28 offset:9216
    s_waitcnt lgkmcnt(0)
    v_mfma_f32_32x32x16_bf16 v[48:63], v[120:123], v[100:103], v[48:63]
    ds_read_b64_tr_b16 v[124:125], v29 offset:8192
    ds_read_b64_tr_b16 v[126:127], v29 offset:9216
    s_waitcnt lgkmcnt(0)
    v_mfma_f32_32x32x16_bf16 v[80:95], v[124:127], v[100:103], v[80:95]
PAD_f_3:
    s_cbranch_execz PAD_f_4
    buffer_load_dwordx4 v[8:11], v5, s[52:55], 0 offen
    buffer_load_dwordx4 v[12:15], v6, s[56:59], 0 offen
    s_mov_b32 s79, 0x8000
L_f_pr:
    buffer_load_dwordx2 v[24:25], v243, s[28:31], 0 offen sc1
    s_sub_u32 s79, s79, 1
    s_waitcnt vmcnt(0)
    v_cmp_ne_u64 vcc, s[26:27], v[24:25]
    s_cmp_eq_u32 s79, 0
    s_cbranch_scc1 L_f_pr_done
    s_cbranch_vccz L_f_pr_done
    s_sleep 8
    s_branch L_f_pr
L_f_pr_done:
    s_or_b32 s74, s2, s65
    s_cmp_lg_u32 s74, 0
    s_cbranch_scc1 L_f_noep
    s_mov_b32 s79, 0x8000
L_f_ep:
    buffer_load_dword v24, v4, s[40:43], 0 offen sc1
    s_sub_u32 s79, s79, 1
    s_waitcnt vmcnt(0)
    v_readfirstlane_b32 s74, v24
    s_cmp_eq_u32 s79, 0
    s_cbranch_scc1 L_f_ep_done
    s_cmp_lg_u32 s74, 256
    s_cbranch_scc1 L_f_ep
L_f_ep_done:
    s_mov_b32 s74, 20971520
    s_mov_b64 exec, 1
    buffer_store_dwordx2 v[236:237], v4, s[28:31], s74 offen sc1
    s_mov_b64 exec, -1
L_f_noep:
    s_add_u32 s14, s15, 4096
    s_mov_b32 s79, 0x10000
    s_mov_b32 s78, 0
    s_mov_b32 s77, 0
    s_mov_b32 s11, 0
L_f_probe:
    s_sub_u32 s79, s79, 1
    s_cmp_eq_u32 s79, 0
    s_cselect_b32 s76, 0, -1
    s_cselect_b32 s79, 1, s79
    buffer_load_dword v25, v244, s[28:31], s15 offen offset:1020 sc1
    s_waitcnt vmcnt(0) lgkmcnt(0)
    v_readfirstlane_b32 s11, v24
    v_cmp_eq_u32 vcc, -1, v25
    s_and_b32 s74, vcc_lo, s76
    s_mov_b32 s75, s78
    s_and_b32 s10, s74, 0x0f0f
    s_cselect_b32 s10, 1, 0
    s_or_b32 s75, s75, s10
    s_and_b32 s10, s74, 0xf0f0
    s_cselect_b32 s10, 2, 0
    s_or_b32 s75, s75, s10
    s_cmp_lg_u32 s75, 3
    s_cbranch_scc1 L_f_load
    s_sleep 2
    s_branch L_f_probe
L_f_load:
    s_bitcmp1_b32 s75, 0
    s_cbranch_scc1 L_f_nl0
    buffer_load_dwordx4 v[96:99], v3, s[28:31], s15 offen offset:0 sc1
    buffer_load_dwordx4 v[100:103], v31, s[28:31], s15 offen offset:0 sc1
    buffer_load_dwordx4 v[104:107], v3, s[28:31], s15 offen offset:1024 sc1
    buffer_load_dwordx4 v[108:111], v31, s[28:31], s15 offen offset:1024 sc1
    buffer_load_dwordx4 v[112:115], v3, s[28:31], s15 offen offset:2048 sc1
    buffer_load_dwordx4 v[116:119], v31, s[28:31], s15 offen offset:2048 sc1
    buffer_load_dwordx4 v[120:123], v3, s[28:31], s15 offen offset:3072 sc1
    buffer_load_dwordx4 v[124:127], v31, s[28:31], s15 offen offset:3072 sc1
L_f_nl0:
    s_bitcmp1_b32 s75, 1
    s_cbranch_scc1 L_f_nl1
    buffer_load_dwordx4 v[128:131], v3, s[28:31], s14 offen offset:0 sc1
    buffer_load_dwordx4 v[132:135], v31, s[28:31], s14 offen offset:0 sc1
    buffer_load_dwordx4 v[136:139], v3, s[28:31], s14 offen offset:1024 sc1
    buffer_load_dwordx4 v[140:143], v31, s[28:31], s14 offen offset:1024 sc1
    buffer_load_dwordx4 v[144:147], v3, s[28:31], s14 offen offset:2048 sc1
    buffer_load_dwordx4 v[148:151], v31, s[28:31], s14 offen offset:2048 sc1
    buffer_load_dwordx4 v[152:155], v3, s[28:31], s14 offen offset:3072 sc1
    buffer_load_dwordx4 v[156:159], v31, s[28:31], s14 offen offset:3072 sc1
L_f_nl1:
    s_bitcmp1_b32 s75, 0
    s_cbranch_scc1 L_f_nc0
    s_bitcmp1_b32 s75, 1
    s_cbranch_scc1 L_f_w0
    s_waitcnt vmcnt(8)
    s_branch L_f_w1
L_f_w0:
    s_waitcnt vmcnt(0)
L_f_w1:
    v_max3_u32 v17, v96, v97, v98
    v_max3_u32 v18, v99, v100, v101
    v_max3_u32 v17, v17, v102, v103
    v_max3_u32 v18, v18, v104, v105
    v_max3_u32 v17, v17, v106, v107
    v_max3_u32 v18, v18, v108, v109
    v_max3_u32 v17, v17, v110, v111
    v_max3_u32 v18, v18, v112, v113
    v_max3_u32 v17, v17, v114, v115
    v_max3_u32 v18, v18, v116, v117
    v_max3_u32 v17, v17, v118, v119
    v_max3_u32 v18, v18, v120, v121
    v_max3_u32 v17, v17, v122, v123
    v_max3_u32 v18, v18, v124, v125
    v_max3_u32 v17, v17, v126, v127
    v_max_u32 v17, v17, v18
    v_and_b32 v17, s76, v17
    v_cmp_eq_u32 vcc, -1, v17
    s_cbranch_vccnz L_f_sk0
    s_bitset1_b32 s78, 0
L_f_nc0:
    s_cmp_lg_u32 s77, 0
    s_cbranch_scc1 L_f_sk0
    s_bitcmp1_b32 s78, 0
    s_cbranch_scc0 L_f_sk0
    s_mov_b32 s77, 1
    v_mfma_f32_32x32x16_bf16 v[32:47], v[160:163], v[96:99], v[32:47]
    v_mfma_f32_32x32x16_bf16 v[48:63], v[160:163], v[100:103], v[48:63]
    v_mfma_f32_32x32x16_bf16 v[64:79], v[164:167], v[96:99], v[64:79]
    v_mfma_f32_32x32x16_bf16 v[80:95], v[164:167], v[100:103], v[80:95]
    v_mfma_f32_32x32x16_bf16 v[32:47], v[168:171], v[104:107], v[32:47]
    v_mfma_f32_32x32x16_bf16 v[48:63], v[168:171], v[108:111], v[48:63]
    v_mfma_f32_32x32x16_bf16 v[64:79], v[172:175], v[104:107], v[64:79]
    v_mfma_f32_32x32x16_bf16 v[80:95], v[172:175], v[108:111], v[80:95]
    v_mfma_f32_32x32x16_bf16 v[32:47], v[176:179], v[112:115], v[32:47]
    v_mfma_f32_32x32x16_bf16 v[48:63], v[176:179], v[116:119], v[48:63]
    v_mfma_f32_32x32x16_bf16 v[64:79], v[180:183], v[112:115], v[64:79]
    v_mfma_f32_32x32x16_bf16 v[80:95], v[180:183], v[116:119], v[80:95]
    v_mfma_f32_32x32x16_bf16 v[32:47], v[184:187], v[120:123], v[32:47]
    v_mfma_f32_32x32x16_bf16 v[48:63], v[184:187], v[124:127], v[48:63]
    v_mfma_f32_32x32x16_bf16 v[64:79], v[188:191], v[120:123], v[64:79]
    v_mfma_f32_32x32x16_bf16 v[80:95], v[188:191], v[124:127], v[80:95]
L_f_sk0:
    s_bitcmp1_b32 s75, 1
    s_cbranch_scc1 L_f_nc1
    s_waitcnt vmcnt(0)
    v_max3_u32 v17, v128, v129, v130
    v_max3_u32 v18, v131, v132, v133
    v_max3_u32 v17, v17, v134, v135
    v_max3_u32 v18, v18, v136, v137
    v_max3_u32 v17, v17, v138, v139
    v_max3_u32 v18, v18, v140, v141
    v_max3_u32 v17, v17, v142, v143
    v_max3_u32 v18, v18, v144, v145
    v_max3_u32 v17, v17, v146, v147
    v_max3_u32 v18, v18, v148, v149
    v_max3_u32 v17, v17, v150, v151
    v_max3_u32 v18, v18, v152, v153
    v_max3_u32 v17, v17, v154, v155
    v_max3_u32 v18, v18, v156, v157
    v_max3_u32 v17, v17, v158, v159
    v_max_u32 v17, v17, v18
    v_and_b32 v17, s76, v17
    v_cmp_eq_u32 vcc, -1, v17
    s_cbranch_vccnz L_f_sk1
    s_bitset1_b32 s78, 1
L_f_nc1:
    s_cmp_lg_u32 s77, 1
    s_cbranch_scc1 L_f_sk1
    s_bitcmp1_b32 s78, 1
    s_cbranch_scc0 L_f_sk1
    s_mov_b32 s77, 2
    v_mfma_f32_32x32x16_bf16 v[32:47], v[192:195], v[128:131], v[32:47]
    v_mfma_f32_32x32x16_bf16 v[48:63], v[192:195], v[132:135], v[48:63]
    v_mfma_f32_32x32x16_bf16 v[64:79], v[196:199], v[128:131], v[64:79]
    v_mfma_f32_32x32x16_bf16 v[80:95], v[196:199], v[132:135], v[80:95]
    v_mfma_f32_32x32x16_bf16 v[32:47], v[200:203], v[136:139], v[32:47]
    v_mfma_f32_32x32x16_bf16 v[48:63], v[200:203], v[140:143], v[48:63]
    v_mfma_f32_32x32x16_bf16 v[64:79], v[204:207], v[136:139], v[64:79]
    v_mfma_f32_32x32x16_bf16 v[80:95], v[204:207], v[140:143], v[80:95]
    v_mfma_f32_32x32x16_bf16 v[32:47], v[208:211], v[144:147], v[32:47]
    v_mfma_f32_32x32x16_bf16 v[48:63], v[208:211], v[148:151], v[48:63]
    v_mfma_f32_32x32x16_bf16 v[64:79], v[212:215], v[144:147], v[64:79]
    v_mfma_f32_32x32x16_bf16 v[80:95], v[212:215], v[148:151], v[80:95]
    v_mfma_f32_32x32x16_bf16 v[32:47], v[216:219], v[152:155], v[32:47]
    v_mfma_f32_32x32x16_bf16 v[48:63], v[216:219], v[156:159], v[48:63]
    v_mfma_f32_32x32x16_bf16 v[64:79], v[220:223], v[152:155], v[64:79]
    v_mfma_f32_32x32x16_bf16 v[80:95], v[220:223], v[156:159], v[80:95]
L_f_sk1:
    s_cmp_lg_u32 s77, 2
    s_cbranch_scc1 L_f_probe
L_f_dw:
    ds_read_b32 v24, v245
    s_waitcnt lgkmcnt(0)
    v_readfirstlane_b32 s74, v24
    s_cmp_eq_u32 s74, 4
    s_cbranch_scc1 L_f_dw_done
    s_sleep 1
    s_branch L_f_dw
L_f_dw_done:
    s_nop 11
    ds_write_b128 v246, v[32:35] offset:0
    ds_write_b128 v246, v[36:39] offset:1088
    ds_write_b128 v246, v[40:43] offset:2176
    ds_write_b128 v246, v[44:47] offset:3264
PAD_f_4:
    s_cbranch_execz L_tour_ret
    ds_write_b128 v246, v[48:51] offset:4352
    ds_write_b128 v246, v[52:55] offset:5440
    ds_write_b128 v246, v[56:59] offset:6528
    ds_write_b128 v246, v[60:63] offset:7616
    ds_write_b128 v246, v[64:67] offset:8704
    ds_write_b128 v246, v[68:71] offset:9792
    ds_write_b128 v246, v[72:75] offset:10880
    ds_write_b128 v246, v[76:79] offset:11968
    ds_write_b128 v246, v[80:83] offset:13056
    ds_write_b128 v246, v[84:87] offset:14144
    ds_write_b128 v246, v[88:91] offset:15232
    ds_write_b128 v246, v[92:95] offset:16320
    s_nop 0
L_final:
    v_and_b32 v16, 3, v1
    v_bfe_u32 v17, v1, 2, 1
    v_lshl_add_u32 v16, v17, 3, v16
    v_mul_u32_u24 v16, 1088, v16
    v_lshrrev_b32 v17, 3, v1
    v_lshl_add_u32 v16, v17, 4, v16
    s_lshr_b32 s74, s64, 2
    s_mul_i32 s74, s74, 4352
    s_lshl_b32 s75, s65, 7
    s_add_u32 s74, s74, s75
    v_add_u32 v16, s74, v16
    s_mov_b32 s75, 0xffff0000
    v_lshlrev_b32 v20, 16, v8
    v_and_b32 v21, s75, v8
    v_lshlrev_b32 v28, 16, v12
    v_and_b32 v29, s75, v12
    v_add_f32 v20, v20, v28
    v_add_f32 v21, v21, v29
    v_lshlrev_b32 v22, 16, v9
    v_and_b32 v23, s75, v9
    v_lshlrev_b32 v28, 16, v13
    v_and_b32 v29, s75, v13
    v_add_f32 v22, v22, v28
    v_add_f32 v23, v23, v29
    v_lshlrev_b32 v24, 16, v10
    v_and_b32 v25, s75, v10
    v_lshlrev_b32 v28, 16, v14
    v_and_b32 v29, s75, v14
    v_add_f32 v24, v24, v28
    v_add_f32 v25, v25, v29
    v_lshlrev_b32 v26, 16, v11
    v_and_b32 v27, s75, v11
    v_lshlrev_b32 v28, 16, v15
    v_and_b32 v29, s75, v15
    v_add_f32 v26, v26, v28
    v_add_f32 v27, v27, v29
    s_waitcnt lgkmcnt(0)
    s_barrier
    ds_read_b128 v[96:99], v16 offset:0
    ds_read_b128 v[100:103], v16 offset:512
    ds_read_b128 v[104:107], v16 offset:17408
    ds_read_b128 v[108:111], v16 offset:17920
    ds_read_b128 v[112:115], v16 offset:34816
    ds_read_b128 v[116:119], v16 offset:35328
    ds_read_b128 v[120:123], v16 offset:52224
    ds_read_b128 v[124:127], v16 offset:52736
    s_waitcnt lgkmcnt(6)
    v_pk_add_f32 v[20:21], v[20:21], v[96:97]
    v_pk_add_f32 v[22:23], v[22:23], v[98:99]
    v_pk_add_f32 v[24:25], v[24:25], v[100:101]
    v_pk_add_f32 v[26:27], v[26:27], v[102:103]
    s_waitcnt lgkmcnt(4)
    v_pk_add_f32 v[20:21], v[20:21], v[104:105]
    v_pk_add_f32 v[22:23], v[22:23], v[106:107]
    v_pk_add_f32 v[24:25], v[24:25], v[108:109]
    v_pk_add_f32 v[26:27], v[26:27], v[110:111]
    s_waitcnt lgkmcnt(2)
    v_pk_add_f32 v[20:21], v[20:21], v[112:113]
    v_pk_add_f32 v[22:23], v[22:23], v[114:115]
    v_pk_add_f32 v[24:25], v[24:25], v[116:117]
    v_pk_add_f32 v[26:27], v[26:27], v[118:119]
    s_waitcnt lgkmcnt(0)
    v_pk_add_f32 v[20:21], v[20:21], v[120:121]
    v_pk_add_f32 v[22:23], v[22:23], v[122:123]
    v_pk_add_f32 v[24:25], v[24:25], v[124:125]
    v_pk_add_f32 v[26:27], v[26:27], v[126:127]
    v_cvt_pk_bf16_f32 v28, v20, v21
    v_cvt_pk_bf16_f32 v29, v22, v23
    v_cvt_pk_bf16_f32 v30, v24, v25
    v_cvt_pk_bf16_f32 v31, v26, v27
    buffer_store_dwordx4 v[28:31], v5, s[60:63], 0 offen
L_end:
    s_endpgm
L_m:
    s_mov_b32 s54, 0x200000
    s_mov_b32 s55, 0x00020000
    v_bfe_u32 v24, v1, 1, 3
    v_xor_b32 v24, v24, v7
    v_lshlrev_b32 v8, 7, v2
    v_lshl_add_u32 v8, v24, 4, v8
    s_lshl_b32 s74, s65, 12
    v_add_u32 v8, s74, v8
    s_waitcnt lgkmcnt(0)
    s_mov_b32 s28, s24
    s_mov_b32 s29, s25
    s_mov_b32 s52, s4
    s_mov_b32 s53, s5
    buffer_load_dwordx2 v[242:243], v4, s[28:31], s3 offen sc1
    s_mov_b32 s48, s8
    s_mov_b32 s49, s9
    s_lshl_b32 s74, s70, 3
    s_lshl_b32 s75, s65, 1
    s_add_u32 s74, s74, s75
    s_mul_i32 s8, s74, 147456
    s_lshl_b32 s75, s69, 10
    s_add_u32 s8, s8, s75
    s_add_u32 s8, s8, 8388608
    s_add_u32 s9, s8, 147456
    s_lshr_b32 s4, s65, 1
    s_and_b32 s5, s65, 1
    s_lshl_b32 s74, s66, 2
    s_add_u32 s6, s74, s65
    s_xor_b32 s7, s6, 1
    v_xor_b32 v9, 32, v8
    v_xor_b32 v10, 64, v8
    v_xor_b32 v11, 96, v8
    v_xor_b32 v12, 0x1000, v8
    v_xor_b32 v13, 0x1000, v9
    v_xor_b32 v14, 0x1000, v10
    v_xor_b32 v15, 0x1000, v11
    v_lshlrev_b32 v17, 3, v7
    v_bfe_u32 v24, v1, 2, 2
    v_add_u32 v17, v17, v24
    v_lshlrev_b32 v17, 6, v17
    v_bfe_u32 v24, v1, 4, 1
    v_lshl_add_u32 v17, v24, 5, v17
    v_and_b32 v24, 3, v1
    v_lshl_add_u32 v17, v24, 3, v17
    v_mov_b64 v[68:69], 0
    v_mov_b64 v[70:71], 0
    v_mov_b64 v[72:73], 0
    v_mov_b64 v[74:75], 0
    v_mov_b64 v[76:77], 0
    v_mov_b64 v[78:79], 0
    v_mov_b64 v[80:81], 0
    v_mov_b64 v[82:83], 0
    v_mov_b64 v[84:85], 0
    v_mov_b64 v[86:87], 0
    v_mov_b64 v[88:89], 0
    v_mov_b64 v[90:91], 0
    v_mov_b64 v[92:93], 0
    v_mov_b64 v[94:95], 0
    v_mov_b64 v[96:97], 0
    v_mov_b64 v[98:99], 0
    v_mov_b64 v[100:101], 0
    v_mov_b64 v[102:103], 0
    v_mov_b64 v[104:105], 0
    v_mov_b64 v[106:107], 0
    v_mov_b64 v[108:109], 0
    v_mov_b64 v[110:111], 0
    v_mov_b64 v[112:113], 0
    v_mov_b64 v[114:115], 0
    v_mov_b64 v[116:117], 0
    v_mov_b64 v[118:119], 0
    v_mov_b64 v[120:121], 0
    v_mov_b64 v[122:123], 0
    v_mov_b64 v[124:125], 0
    v_mov_b64 v[126:127], 0
    v_mov_b64 v[128:129], 0
    v_mov_b64 v[130:131], 0
    v_mov_b64 v[132:133], 0
    v_mov_b64 v[134:135], 0
    v_mov_b64 v[136:137], 0
    v_mov_b64 v[138:139], 0
    v_mov_b64 v[140:141], 0
    v_mov_b64 v[142:143], 0
    v_mov_b64 v[144:145], 0
    v_mov_b64 v[146:147], 0
    v_mov_b64 v[148:149], 0
    v_mov_b64 v[150:151], 0
    v_mov_b64 v[152:153], 0
    v_mov_b64 v[154:155], 0
    v_mov_b64 v[156:157], 0
    v_mov_b64 v[158:159], 0
    v_mov_b64 v[160:161], 0
    v_mov_b64 v[162:163], 0
    v_mov_b64 v[164:165], 0
    v_mov_b64 v[166:167], 0
    v_mov_b64 v[168:169], 0
    v_mov_b64 v[170:171], 0
    v_mov_b64 v[172:173], 0
    v_mov_b64 v[174:175], 0
    v_mov_b64 v[176:177], 0
    v_mov_b64 v[178:179], 0
    v_mov_b64 v[182:183], 0
    v_mov_b64 v[186:187], 0
    v_mov_b64 v[190:191], 0
    v_mov_b64 v[194:195], 0
    v_mov_b64 v[198:199], 0
    v_mov_b64 v[202:203], 0
    v_and_b32 v247, 15, v1
    v_lshlrev_b32 v247, 4, v247
    v_lshl_add_u32 v247, v7, 8, v247
    v_and_b32 v56, 16, v1
    v_cmp_eq_u32 vcc, 0, v56
    v_and_b32 v57, 11, v1
    v_cmp_ne_u32 s[74:75], 0, v57
    v_add_u32 v245, 65536, v247
    v_add_u32 v246, 66048, v247
    v_mov_b32 v56, 66560
    v_mov_b32 v57, 66576
    v_cndmask_b32 v56, v56, v57, s[74:75]
    v_cndmask_b32 v245, v56, v245, vcc
    v_cndmask_b32 v246, v56, v246, vcc
    v_and_b32 v244, 0x33, v1
    v_bfe_u32 v56, v1, 2, 1
    v_lshl_add_u32 v244, v56, 3, v244
    v_bfe_u32 v56, v1, 3, 1
    v_lshl_add_u32 v244, v56, 2, v244
    v_lshlrev_b32 v244, 4, v244
    v_mov_b32 v248, 159808
    s_lshl_b32 s74, s65, 11
    s_add_u32 s74, s74, 135232
    v_add_u32 v249, s74, v3
    s_lshl_b32 s74, s65, 2
    s_add_u32 s74, s74, 159872
    v_mov_b32 v18, s74
    v_mov_b32 v19, 1
    s_lshl_b32 s74, s71, 3
    s_add_u32 s74, s74, s64
    s_lshl_b32 s74, s74, 13
    v_lshrrev_b32 v5, 3, v1
    v_lshlrev_b32 v5, 10, v5
    v_and_b32 v6, 7, v1
    s_lshl_b32 s75, s72, 7
    v_lshl_add_u32 v6, v6, 4, s75
    v_add3_u32 v5, v5, v6, s74
    s_mov_b32 s56, s18
    s_mov_b32 s57, s19
    s_mov_b32 s58, 1024
    s_mov_b32 s59, 0x00020000
    s_mov_b32 s60, s20
    s_mov_b32 s61, s21
    s_mov_b32 s62, 0x200000
    s_mov_b32 s63, 0x00020000
    s_waitcnt vmcnt(0)
    s_cmp_lt_u32 s2, 224
    s_cbranch_scc1 L_m_nt
    s_cmp_lg_u32 s65, 0
    s_cbranch_scc1 L_m_nt
    v_lshlrev_b32 v24, 20, v1
    buffer_load_dword v253, v24, s[28:31], 0 offen
    global_load_dword v253, v4, s[48:49]
    global_load_dword v253, v4, s[14:15]
    global_load_dword v253, v4, s[16:17]
    global_load_dword v253, v4, s[18:19]
    global_load_dword v253, v4, s[20:21]
    global_load_dword v253, v4, s[22:23]
L_m_nt:
    s_lshl_b32 s74, s65, 1
    s_add_u32 s74, s74, s68
    s_mov_b64 exec, 0
    s_cmp_eq_u32 s74, 0
    s_cbranch_scc1 TOUR_mq
    s_cmp_eq_u32 s74, 1
    s_cbranch_scc1 TOUR_mf
    s_cmp_lt_u32 s74, 4
    s_cbranch_scc1 TOUR_h
    s_cmp_lt_u32 s74, 6
    s_cbranch_scc1 TOUR_a
    s_branch TOUR_f
L_tour_ret:
    s_mov_b64 exec, -1
    s_mov_b32 s10, 0
    s_mov_b32 s11, 8
    s_mov_b32 s14, 16384
    s_mov_b32 s15, 28672
    v_add_u32 v242, 1, v242
    v_add_u32 v243, 1, v243
    s_setprio 2
    s_cmp_lg_u32 s68, 0
    s_cbranch_scc1 L_m_ffn
L_m_qkv:
TOUR_mq:
    s_cbranch_execz PAD_mq_1
    s_lshl_b32 s74, s5, 12
    s_add_u32 s74, s74, 49152
    v_add_u32 v16, s74, v17
    s_lshl_b32 s74, s67, 1
    s_add_u32 s74, s74, s5
    s_lshl_b32 s74, s74, 4
    s_add_u32 s74, s74, s66
    s_lshl_b32 s74, s74, 1
    s_add_u32 s74, s74, s4
    s_lshl_b32 s74, s74, 3
    s_add_u32 s74, s74, 20979712
    v_lshl_add_u32 v240, v3, 4, s74
    v_mov_b32 v241, 159904
    s_barrier
    ds_read_b128 v[20:23], v8
    ds_read_b64_tr_b16 v[28:29], v16 offset:0
    ds_read_b64_tr_b16 v[30:31], v16 offset:256
    ds_read_b128 v[24:27], v12
    ds_read_b64_tr_b16 v[32:33], v16 offset:8192
    ds_read_b64_tr_b16 v[34:35], v16 offset:8448
    ds_read_b64_tr_b16 v[36:37], v16 offset:16384
    ds_read_b64_tr_b16 v[38:39], v16 offset:16640
.p2align 6
L_m_qkv_loop:
    s_waitcnt lgkmcnt(0)
    v_mfma_f32_32x32x16_bf16 v[68:83], v[28:31], v[20:23], v[68:83]
    ds_read_b128 v[44:47], v9
    ds_read_b64_tr_b16 v[52:53], v16 offset:1024
    ds_read_b64_tr_b16 v[54:55], v16 offset:1280
    v_mfma_f32_32x32x16_bf16 v[84:99], v[28:31], v[24:27], v[84:99]
    ds_read_b128 v[48:51], v13
    ds_read_b64_tr_b16 v[56:57], v16 offset:9216
    ds_read_b64_tr_b16 v[58:59], v16 offset:9472
    v_mfma_f32_32x32x16_bf16 v[100:115], v[32:35], v[20:23], v[100:115]
    ds_read_b64_tr_b16 v[60:61], v16 offset:17408
    ds_read_b64_tr_b16 v[62:63], v16 offset:17664
    s_add_u32 s10, s10, 1
    v_mfma_f32_32x32x16_bf16 v[116:131], v[32:35], v[24:27], v[116:131]
    s_cmp_eq_u32 s10, 3
    s_cselect_b32 s12, -32768, s14
    s_cselect_b32 s13, -57344, s15
    v_mfma_f32_32x32x16_bf16 v[132:147], v[20:23], v[36:39], v[132:147]
    s_cselect_b32 s10, 0, s10
    v_mfma_f32_32x32x16_bf16 v[148:163], v[24:27], v[36:39], v[148:163]
    s_waitcnt lgkmcnt(0)
    v_mfma_f32_32x32x16_bf16 v[68:83], v[52:55], v[44:47], v[68:83]
    ds_read_b128 v[20:23], v10
    ds_read_b64_tr_b16 v[28:29], v16 offset:2048
    ds_read_b64_tr_b16 v[30:31], v16 offset:2304
    v_mfma_f32_32x32x16_bf16 v[84:99], v[52:55], v[48:51], v[84:99]
    ds_read_b128 v[24:27], v14
    ds_read_b64_tr_b16 v[32:33], v16 offset:10240
    ds_read_b64_tr_b16 v[34:35], v16 offset:10496
    v_mfma_f32_32x32x16_bf16 v[100:115], v[56:59], v[44:47], v[100:115]
    ds_read_b64_tr_b16 v[36:37], v16 offset:18432
    ds_read_b64_tr_b16 v[38:39], v16 offset:18688
    v_mfma_f32_32x32x16_bf16 v[116:131], v[56:59], v[48:51], v[116:131]
    v_mfma_f32_32x32x16_bf16 v[132:147], v[44:47], v[60:63], v[132:147]
    v_mfma_f32_32x32x16_bf16 v[148:163], v[48:51], v[60:63], v[148:163]
    s_waitcnt lgkmcnt(0)
    v_mfma_f32_32x32x16_bf16 v[68:83], v[28:31], v[20:23], v[68:83]
    ds_read_b128 v[44:47], v11
    ds_read_b64_tr_b16 v[52:53], v16 offset:3072
    ds_read_b64_tr_b16 v[54:55], v16 offset:3328
    v_mfma_f32_32x32x16_bf16 v[84:99], v[28:31], v[24:27], v[84:99]
    ds_read_b128 v[48:51], v15
    ds_read_b64_tr_b16 v[56:57], v16 offset:11264
    ds_read_b64_tr_b16 v[58:59], v16 offset:11520
    v_mfma_f32_32x32x16_bf16 v[100:115], v[32:35], v[20:23], v[100:115]
    ds_read_b64_tr_b16 v[60:61], v16 offset:19456
    ds_read_b64_tr_b16 v[62:63], v16 offset:19712
    s_sub_u32 s11, s11, 1
    v_mfma_f32_32x32x16_bf16 v[116:131], v[32:35], v[24:27], v[116:131]
    s_cmp_eq_u32 s11, 0
    v_mfma_f32_32x32x16_bf16 v[132:147], v[20:23], v[36:39], v[132:147]
    v_mfma_f32_32x32x16_bf16 v[148:163], v[24:27], v[36:39], v[148:163]
    s_waitcnt lgkmcnt(0)
    v_mfma_f32_32x32x16_bf16 v[68:83], v[52:55], v[44:47], v[68:83]
    s_barrier
    s_cbranch_scc1 L_m_qkv_last
    v_add_u32 v8, s12, v8
    v_add_u32 v16, s13, v16
    v_add_u32 v12, s12, v12
    v_mfma_f32_32x32x16_bf16 v[84:99], v[52:55], v[48:51], v[84:99]
    ds_read_b128 v[20:23], v8
    ds_read_b64_tr_b16 v[28:29], v16 offset:0
    ds_read_b64_tr_b16 v[30:31], v16 offset:256
    v_mfma_f32_32x32x16_bf16 v[100:115], v[56:59], v[44:47], v[100:115]
    ds_read_b128 v[24:27], v12
    ds_read_b64_tr_b16 v[32:33], v16 offset:8192
    ds_read_b64_tr_b16 v[34:35], v16 offset:8448
    v_mfma_f32_32x32x16_bf16 v[116:131], v[56:59], v[48:51], v[116:131]
    ds_read_b64_tr_b16 v[36:37], v16 offset:16384
    ds_read_b64_tr_b16 v[38:39], v16 offset:16640
    v_add_u32 v9, s12, v9
    v_mfma_f32_32x32x16_bf16 v[132:147], v[44:47], v[60:63], v[132:147]
    v_add_u32 v13, s12, v13
    v_add_u32 v10, s12, v10
    v_add_u32 v14, s12, v14
    v_mfma_f32_32x32x16_bf16 v[148:163], v[48:51], v[60:63], v[148:163]
    v_add_u32 v11, s12, v11
    v_add_u32 v15, s12, v15
    s_branch L_m_qkv_loop
L_m_qkv_last:
    s_lshl_b32 s74, s65, 8
    v_lshl_add_u32 v8, v2, 3, s74
    v_xor_b32 v9, 0x100, v8
    v_lshrrev_b32 v10, 1, v8
    v_lshrrev_b32 v11, 1, v9
    v_mfma_f32_32x32x16_bf16 v[84:99], v[52:55], v[48:51], v[84:99]
    s_mul_i32 s74, s5, 256
    v_lshl_add_u32 v12, v2, 3, s74
    v_add_u32 v8, 159936, v8
    v_add_u32 v9, 159936, v9
    v_add_u32 v10, 160960, v10
    v_add_u32 v11, 160960, v11
    v_mfma_f32_32x32x16_bf16 v[100:115], v[56:59], v[44:47], v[100:115]
    v_add_u32 v12, 161984, v12
    s_lshl_b32 s74, s65, 7
    v_lshl_add_u32 v14, v7, 4, s74
    v_xor_b32 v15, 0x80, v14
    v_add_u32 v14, 160960, v14
    v_add_u32 v15, 160960, v15
    v_mfma_f32_32x32x16_bf16 v[116:131], v[56:59], v[48:51], v[116:131]
    ds_read_b64 v[180:181], v8
    ds_read_b64 v[184:185], v9
    ds_read_b64 v[188:189], v12 offset:0
    ds_read_b64 v[192:193], v12 offset:512
    ds_read_b64 v[196:197], v12 offset:1024
    ds_read_b32 v204, v10
    v_mfma_f32_32x32x16_bf16 v[132:147], v[44:47], v[60:63], v[132:147]
    ds_read_b32 v205, v11
    ds_read_b128 v[208:211], v14 offset:0
    ds_read_b128 v[212:215], v14 offset:32
    ds_read_b128 v[216:219], v14 offset:64
    ds_read_b128 v[220:223], v14 offset:96
    ds_read_b128 v[224:227], v15 offset:0
    v_mfma_f32_32x32x16_bf16 v[148:163], v[48:51], v[60:63], v[148:163]
    ds_read_b128 v[228:231], v15 offset:32
    ds_read_b128 v[232:235], v15 offset:64
    ds_read_b128 v[236:239], v15 offset:96
    s_lshl_b32 s74, s67, 1
    s_add_u32 s74, s74, s5
    s_lshl_b32 s74, s74, 17
    s_lshl_b32 s12, s6, 10
    s_add_u32 s12, s12, s74
    s_lshl_b32 s13, s7, 10
    s_add_u32 s13, s13, s74
    s_waitcnt lgkmcnt(10)
    v_mfma_f32_32x32x16_bf16 v[100:115], v[192:195], v[180:183], v[100:115]
    s_waitcnt lgkmcnt(0)
    v_mfma_f32_32x32x16_bf16 v[116:131], v[192:195], v[184:187], v[116:131]
    v_mfma_f32_32x32x16_bf16 v[132:147], v[180:183], v[196:199], v[132:147]
    v_mfma_f32_32x32x16_bf16 v[148:163], v[184:187], v[196:199], v[148:163]
    v_mfma_f32_32x32x16_bf16 v[68:83], v[188:191], v[180:183], v[68:83]
    v_mfma_f32_32x32x16_bf16 v[84:99], v[188:191], v[184:187], v[84:99]
    v_mov_b32 v12, v204
    v_mov_b32 v13, v204
    v_mov_b32 v14, v205
    v_mov_b32 v15, v205
    v_mul_f32 v204, 0x3eb8aa3b, v12
    v_mul_f32 v205, 0x3eb8aa3b, v12
    v_mul_f32 v206, 0x3eb8aa3b, v14
    v_mul_f32 v207, 0x3eb8aa3b, v14
    v_bfe_u32 v8, v1, 4, 1
PAD_mq_1:
    s_cbranch_execz L_tour_ret
    v_lshlrev_b32 v8, 16, v8
    v_lshl_add_u32 v8, v7, 8, v8
    v_and_b32 v9, 15, v1
    v_lshl_add_u32 v8, v9, 4, v8
    v_pk_mul_f32 v[100:101], v[100:101], v[12:13]
    v_pk_mul_f32 v[102:103], v[102:103], v[12:13]
    v_pk_mul_f32 v[104:105], v[104:105], v[12:13]
    v_pk_mul_f32 v[106:107], v[106:107], v[12:13]
    v_pk_mul_f32 v[108:109], v[108:109], v[12:13]
    v_pk_mul_f32 v[110:111], v[110:111], v[12:13]
    v_pk_mul_f32 v[112:113], v[112:113], v[12:13]
    v_pk_mul_f32 v[114:115], v[114:115], v[12:13]
    v_cvt_pk_bf16_f32 v20, v100, v101
    v_cvt_pk_bf16_f32 v21, v102, v103
    v_cvt_pk_bf16_f32 v22, v104, v105
    v_cvt_pk_bf16_f32 v23, v106, v107
    v_cvt_pk_bf16_f32 v24, v108, v109
    v_cvt_pk_bf16_f32 v25, v110, v111
    v_cvt_pk_bf16_f32 v26, v112, v113
    v_cvt_pk_bf16_f32 v27, v114, v115
    s_add_u32 s74, s12, 2097152
    buffer_store_dwordx4 v[20:23], v3, s[28:31], s74 offen sc1
    s_add_u32 s74, s12, 2162688
    buffer_store_dwordx4 v[24:27], v3, s[28:31], s74 offen sc1
    v_pk_mul_f32 v[116:117], v[116:117], v[14:15]
    v_pk_mul_f32 v[118:119], v[118:119], v[14:15]
    v_pk_mul_f32 v[120:121], v[120:121], v[14:15]
    v_pk_mul_f32 v[122:123], v[122:123], v[14:15]
    v_pk_mul_f32 v[124:125], v[124:125], v[14:15]
    v_pk_mul_f32 v[126:127], v[126:127], v[14:15]
    v_pk_mul_f32 v[128:129], v[128:129], v[14:15]
    v_pk_mul_f32 v[130:131], v[130:131], v[14:15]
    v_cvt_pk_bf16_f32 v28, v116, v117
    v_cvt_pk_bf16_f32 v29, v118, v119
    v_cvt_pk_bf16_f32 v30, v120, v121
    v_cvt_pk_bf16_f32 v31, v122, v123
    v_cvt_pk_bf16_f32 v32, v124, v125
    v_cvt_pk_bf16_f32 v33, v126, v127
    v_cvt_pk_bf16_f32 v34, v128, v129
    v_cvt_pk_bf16_f32 v35, v130, v131
    s_add_u32 s74, s13, 2097152
    buffer_store_dwordx4 v[28:31], v3, s[28:31], s74 offen sc1
    s_add_u32 s74, s13, 2162688
    buffer_store_dwordx4 v[32:35], v3, s[28:31], s74 offen sc1
    v_pk_mul_f32 v[132:133], v[132:133], v[208:209]
    v_pk_mul_f32 v[134:135], v[134:135], v[210:211]
    v_pk_mul_f32 v[136:137], v[136:137], v[212:213]
    v_pk_mul_f32 v[138:139], v[138:139], v[214:215]
    v_pk_mul_f32 v[140:141], v[140:141], v[216:217]
    v_pk_mul_f32 v[142:143], v[142:143], v[218:219]
    v_pk_mul_f32 v[144:145], v[144:145], v[220:221]
    v_pk_mul_f32 v[146:147], v[146:147], v[222:223]
    v_cvt_pk_bf16_f32 v36, v132, v133
    v_cvt_pk_bf16_f32 v37, v134, v135
    v_cvt_pk_bf16_f32 v38, v136, v137
    v_cvt_pk_bf16_f32 v39, v138, v139
    v_cvt_pk_bf16_f32 v40, v140, v141
    v_cvt_pk_bf16_f32 v41, v142, v143
    v_cvt_pk_bf16_f32 v42, v144, v145
    v_cvt_pk_bf16_f32 v43, v146, v147
    s_add_u32 s74, s12, 4194304
    buffer_store_dwordx4 v[36:39], v8, s[28:31], s74 offen offset:0 sc1
    buffer_store_dwordx4 v[40:43], v8, s[28:31], s74 offen offset:512 sc1
    v_pk_mul_f32 v[148:149], v[148:149], v[224:225]
    v_pk_mul_f32 v[150:151], v[150:151], v[226:227]
    v_pk_mul_f32 v[152:153], v[152:153], v[228:229]
    v_pk_mul_f32 v[154:155], v[154:155], v[230:231]
    v_pk_mul_f32 v[156:157], v[156:157], v[232:233]
    v_pk_mul_f32 v[158:159], v[158:159], v[234:235]
    v_pk_mul_f32 v[160:161], v[160:161], v[236:237]
    v_pk_mul_f32 v[162:163], v[162:163], v[238:239]
    v_cvt_pk_bf16_f32 v44, v148, v149
    v_cvt_pk_bf16_f32 v45, v150, v151
    v_cvt_pk_bf16_f32 v46, v152, v153
    v_cvt_pk_bf16_f32 v47, v154, v155
    v_cvt_pk_bf16_f32 v48, v156, v157
    v_cvt_pk_bf16_f32 v49, v158, v159
    v_cvt_pk_bf16_f32 v50, v160, v161
    v_cvt_pk_bf16_f32 v51, v162, v163
    s_add_u32 s74, s13, 4194304
    buffer_store_dwordx4 v[44:47], v8, s[28:31], s74 offen offset:0 sc1
    buffer_store_dwordx4 v[48:51], v8, s[28:31], s74 offen offset:512 sc1
    v_pk_mul_f32 v[68:69], v[68:69], v[204:205]
    v_pk_mul_f32 v[70:71], v[70:71], v[204:205]
    v_pk_mul_f32 v[72:73], v[72:73], v[204:205]
    v_pk_mul_f32 v[74:75], v[74:75], v[204:205]
    v_pk_mul_f32 v[76:77], v[76:77], v[204:205]
    v_pk_mul_f32 v[78:79], v[78:79], v[204:205]
    v_pk_mul_f32 v[80:81], v[80:81], v[204:205]
    v_pk_mul_f32 v[82:83], v[82:83], v[204:205]
    v_cvt_pk_bf16_f32 v52, v68, v69
    v_cvt_pk_bf16_f32 v53, v70, v71
    v_cvt_pk_bf16_f32 v54, v72, v73
    v_cvt_pk_bf16_f32 v55, v74, v75
    v_cvt_pk_bf16_f32 v56, v76, v77
    v_cvt_pk_bf16_f32 v57, v78, v79
    v_cvt_pk_bf16_f32 v58, v80, v81
    v_cvt_pk_bf16_f32 v59, v82, v83
    s_add_u32 s74, s12, 0
    buffer_store_dwordx4 v[52:55], v3, s[28:31], s74 offen sc1
    s_add_u32 s74, s12, 65536
    buffer_store_dwordx4 v[56:59], v3, s[28:31], s74 offen sc1
    v_pk_mul_f32 v[84:85], v[84:85], v[206:207]
    v_pk_mul_f32 v[86:87], v[86:87], v[206:207]
    v_pk_mul_f32 v[88:89], v[88:89], v[206:207]
    v_pk_mul_f32 v[90:91], v[90:91], v[206:207]
    v_pk_mul_f32 v[92:93], v[92:93], v[206:207]
    v_pk_mul_f32 v[94:95], v[94:95], v[206:207]
    v_pk_mul_f32 v[96:97], v[96:97], v[206:207]
    v_pk_mul_f32 v[98:99], v[98:99], v[206:207]
    v_cvt_pk_bf16_f32 v60, v84, v85
    v_cvt_pk_bf16_f32 v61, v86, v87
    v_cvt_pk_bf16_f32 v62, v88, v89
    v_cvt_pk_bf16_f32 v63, v90, v91
    v_cvt_pk_bf16_f32 v64, v92, v93
    v_cvt_pk_bf16_f32 v65, v94, v95
    v_cvt_pk_bf16_f32 v66, v96, v97
    v_cvt_pk_bf16_f32 v67, v98, v99
    s_add_u32 s74, s13, 0
    buffer_store_dwordx4 v[60:63], v3, s[28:31], s74 offen sc1
    s_add_u32 s74, s13, 65536
    buffer_store_dwordx4 v[64:67], v3, s[28:31], s74 offen sc1
    s_waitcnt vmcnt(0)
    s_mov_b64 exec, 1
    buffer_store_dwordx2 v[242:243], v240, s[28:31], 0 offen sc1
    s_mov_b64 exec, 1
    ds_add_u32 v241, v19
    s_mov_b64 exec, -1
    s_branch L_a
L_m_ffn:
TOUR_mf:
    s_cbranch_execz PAD_mf_1
    s_mul_i32 s74, s5, 12288
    s_add_u32 s74, s74, 49152
    v_add_u32 v16, s74, v17
    v_add_u32 v17, 73728, v17
    v_lshl_add_u32 v240, v3, 4, s74
    v_mov_b32 v241, 159904
    s_barrier
    ds_read_b128 v[20:23], v8
    ds_read_b64_tr_b16 v[28:29], v16 offset:0
    ds_read_b64_tr_b16 v[30:31], v16 offset:256
    ds_read_b128 v[24:27], v12
    ds_read_b64_tr_b16 v[32:33], v16 offset:4096
    ds_read_b64_tr_b16 v[34:35], v16 offset:4352
    ds_read_b64_tr_b16 v[36:37], v16 offset:8192
    ds_read_b64_tr_b16 v[38:39], v16 offset:8448
    ds_read_b64_tr_b16 v[40:41], v17 offset:0
    ds_read_b64_tr_b16 v[42:43], v17 offset:256
.p2align 6
L_m_ffn_loop:
    s_waitcnt lgkmcnt(0)
    v_mfma_f32_32x32x16_bf16 v[68:83], v[28:31], v[20:23], v[68:83]
    ds_read_b128 v[44:47], v9
    ds_read_b64_tr_b16 v[52:53], v16 offset:1024
    ds_read_b64_tr_b16 v[54:55], v16 offset:1280
    v_mfma_f32_32x32x16_bf16 v[84:99], v[28:31], v[24:27], v[84:99]
    ds_read_b128 v[48:51], v13
    ds_read_b64_tr_b16 v[56:57], v16 offset:5120
    ds_read_b64_tr_b16 v[58:59], v16 offset:5376
    v_mfma_f32_32x32x16_bf16 v[100:115], v[32:35], v[20:23], v[100:115]
    ds_read_b64_tr_b16 v[60:61], v16 offset:9216
    ds_read_b64_tr_b16 v[62:63], v16 offset:9472
    ds_read_b64_tr_b16 v[64:65], v17 offset:1024
    v_mfma_f32_32x32x16_bf16 v[116:131], v[32:35], v[24:27], v[116:131]
    ds_read_b64_tr_b16 v[66:67], v17 offset:1280
    s_add_u32 s10, s10, 1
    s_cmp_eq_u32 s10, 3
    v_mfma_f32_32x32x16_bf16 v[132:147], v[36:39], v[20:23], v[132:147]
    s_cselect_b32 s12, -32768, s14
    s_cselect_b32 s13, -57344, s15
    s_cselect_b32 s10, 0, s10
    v_mfma_f32_32x32x16_bf16 v[148:163], v[36:39], v[24:27], v[148:163]
    v_mfma_f32_32x32x16_bf16 v[164:179], v[40:43], v[20:23], v[164:179]
    s_waitcnt lgkmcnt(0)
    v_mfma_f32_32x32x16_bf16 v[68:83], v[52:55], v[44:47], v[68:83]
    ds_read_b128 v[20:23], v10
    ds_read_b64_tr_b16 v[28:29], v16 offset:2048
    ds_read_b64_tr_b16 v[30:31], v16 offset:2304
    v_mfma_f32_32x32x16_bf16 v[84:99], v[52:55], v[48:51], v[84:99]
    ds_read_b128 v[24:27], v14
    ds_read_b64_tr_b16 v[32:33], v16 offset:6144
    ds_read_b64_tr_b16 v[34:35], v16 offset:6400
    v_mfma_f32_32x32x16_bf16 v[100:115], v[56:59], v[44:47], v[100:115]
    ds_read_b64_tr_b16 v[36:37], v16 offset:10240
    ds_read_b64_tr_b16 v[38:39], v16 offset:10496
    ds_read_b64_tr_b16 v[40:41], v17 offset:2048
    v_mfma_f32_32x32x16_bf16 v[116:131], v[56:59], v[48:51], v[116:131]
    ds_read_b64_tr_b16 v[42:43], v17 offset:2304
    v_mfma_f32_32x32x16_bf16 v[132:147], v[60:63], v[44:47], v[132:147]
    v_mfma_f32_32x32x16_bf16 v[148:163], v[60:63], v[48:51], v[148:163]
    v_mfma_f32_32x32x16_bf16 v[164:179], v[64:67], v[44:47], v[164:179]
    s_waitcnt lgkmcnt(0)
    v_mfma_f32_32x32x16_bf16 v[68:83], v[28:31], v[20:23], v[68:83]
    ds_read_b128 v[44:47], v11
    ds_read_b64_tr_b16 v[52:53], v16 offset:3072
    ds_read_b64_tr_b16 v[54:55], v16 offset:3328
    v_mfma_f32_32x32x16_bf16 v[84:99], v[28:31], v[24:27], v[84:99]
    ds_read_b128 v[48:51], v15
    ds_read_b64_tr_b16 v[56:57], v16 offset:7168
    ds_read_b64_tr_b16 v[58:59], v16 offset:7424
    v_mfma_f32_32x32x16_bf16 v[100:115], v[32:35], v[20:23], v[100:115]
    ds_read_b64_tr_b16 v[60:61], v16 offset:11264
    ds_read_b64_tr_b16 v[62:63], v16 offset:11520
    ds_read_b64_tr_b16 v[64:65], v17 offset:3072
    v_mfma_f32_32x32x16_bf16 v[116:131], v[32:35], v[24:27], v[116:131]
    ds_read_b64_tr_b16 v[66:67], v17 offset:3328
    s_sub_u32 s11, s11, 1
    s_cmp_eq_u32 s11, 0
    v_mfma_f32_32x32x16_bf16 v[132:147], v[36:39], v[20:23], v[132:147]
    v_mfma_f32_32x32x16_bf16 v[148:163], v[36:39], v[24:27], v[148:163]
    v_mfma_f32_32x32x16_bf16 v[164:179], v[40:43], v[20:23], v[164:179]
    s_waitcnt lgkmcnt(0)
    v_mfma_f32_32x32x16_bf16 v[68:83], v[52:55], v[44:47], v[68:83]
    s_barrier
    s_cbranch_scc1 L_m_ffn_last
    v_add_u32 v8, s12, v8
    v_add_u32 v16, s13, v16
    v_add_u32 v12, s12, v12
    v_add_u32 v17, s13, v17
    v_mfma_f32_32x32x16_bf16 v[84:99], v[52:55], v[48:51], v[84:99]
    ds_read_b128 v[20:23], v8
    ds_read_b64_tr_b16 v[28:29], v16 offset:0
    ds_read_b64_tr_b16 v[30:31], v16 offset:256
    v_mfma_f32_32x32x16_bf16 v[100:115], v[56:59], v[44:47], v[100:115]
    ds_read_b128 v[24:27], v12
    ds_read_b64_tr_b16 v[32:33], v16 offset:4096
    ds_read_b64_tr_b16 v[34:35], v16 offset:4352
    v_mfma_f32_32x32x16_bf16 v[116:131], v[56:59], v[48:51], v[116:131]
    ds_read_b64_tr_b16 v[36:37], v16 offset:8192
    ds_read_b64_tr_b16 v[38:39], v16 offset:8448
    ds_read_b64_tr_b16 v[40:41], v17 offset:0
    v_mfma_f32_32x32x16_bf16 v[132:147], v[60:63], v[44:47], v[132:147]
    ds_read_b64_tr_b16 v[42:43], v17 offset:256
    v_add_u32 v9, s12, v9
    v_add_u32 v13, s12, v13
    v_mfma_f32_32x32x16_bf16 v[148:163], v[60:63], v[48:51], v[148:163]
    v_add_u32 v10, s12, v10
    v_add_u32 v14, s12, v14
    v_add_u32 v11, s12, v11
    v_mfma_f32_32x32x16_bf16 v[164:179], v[64:67], v[44:47], v[164:179]
    v_add_u32 v15, s12, v15
    s_branch L_m_ffn_loop
L_m_ffn_last:
    s_lshl_b32 s74, s65, 8
    v_lshl_add_u32 v8, v2, 3, s74
    v_xor_b32 v9, 0x100, v8
    v_lshrrev_b32 v10, 1, v8
    v_lshrrev_b32 v11, 1, v9
    v_mfma_f32_32x32x16_bf16 v[84:99], v[52:55], v[48:51], v[84:99]
    s_mul_i32 s74, s5, 768
    v_lshl_add_u32 v12, v2, 3, s74
    v_add_u32 v8, 159936, v8
    v_add_u32 v9, 159936, v9
    v_add_u32 v10, 160960, v10
    v_add_u32 v11, 160960, v11
    v_mfma_f32_32x32x16_bf16 v[100:115], v[56:59], v[44:47], v[100:115]
    v_add_u32 v12, 161984, v12
    v_lshlrev_b32 v13, 3, v2
    v_add_u32 v13, 163520, v13
    ds_read_b64 v[180:181], v8
    ds_read_b64 v[184:185], v9
    ds_read_b64 v[188:189], v12 offset:0
    v_mfma_f32_32x32x16_bf16 v[116:131], v[56:59], v[48:51], v[116:131]
    ds_read_b64 v[192:193], v12 offset:256
    ds_read_b64 v[196:197], v12 offset:512
    ds_read_b64 v[200:201], v13
    ds_read_b32 v204, v10
    ds_read_b32 v205, v11
    ds_read_b32 v206, v10 offset:512
    v_mfma_f32_32x32x16_bf16 v[132:147], v[60:63], v[44:47], v[132:147]
    ds_read_b32 v207, v11 offset:512
    s_lshl_b32 s74, s65, 10
    s_add_u32 s74, s74, 32768
    v_add_u32 v16, s74, v3
    s_mul_i32 s74, s65, 1056
    s_add_u32 s74, s74, 99328
    v_mfma_f32_32x32x16_bf16 v[148:163], v[60:63], v[48:51], v[148:163]
    v_add_u32 v17, s74, v3
    v_mfma_f32_32x32x16_bf16 v[164:179], v[64:67], v[44:47], v[164:179]
    s_waitcnt lgkmcnt(4)
    v_mfma_f32_32x32x16_bf16 v[68:83], v[188:191], v[180:183], v[68:83]
    s_waitcnt lgkmcnt(0)
    v_mfma_f32_32x32x16_bf16 v[84:99], v[188:191], v[184:187], v[84:99]
    v_mfma_f32_32x32x16_bf16 v[100:115], v[192:195], v[180:183], v[100:115]
    v_mfma_f32_32x32x16_bf16 v[116:131], v[192:195], v[184:187], v[116:131]
    v_mfma_f32_32x32x16_bf16 v[132:147], v[196:199], v[180:183], v[132:147]
    v_mfma_f32_32x32x16_bf16 v[148:163], v[196:199], v[184:187], v[148:163]
    v_mfma_f32_32x32x16_bf16 v[164:179], v[200:203], v[180:183], v[164:179]
PAD_mf_1:
    s_cbranch_execz PAD_mf_2
    v_mul_f32 v8, 0xc0135761, v204
    v_mul_f32 v12, v204, v204
    v_mul_f32 v12, v12, v204
    v_mul_f32 v12, 0xbdd2d3e8, v12
    v_mov_b32 v9, v8
    v_mov_b32 v13, v12
    v_mov_b32 v20, v206
    v_mov_b32 v21, v206
    v_mul_f32 v10, 0xc0135761, v205
    v_mul_f32 v14, v205, v205
    v_mul_f32 v14, v14, v205
    v_mul_f32 v14, 0xbdd2d3e8, v14
    v_mov_b32 v11, v10
    v_mov_b32 v15, v14
    v_mov_b32 v22, v207
    v_mov_b32 v23, v207
    v_pk_mul_f32 v[24:25], v[68:69], v[68:69]
    v_pk_mul_f32 v[26:27], v[70:71], v[70:71]
    v_pk_mul_f32 v[28:29], v[72:73], v[72:73]
    v_pk_mul_f32 v[30:31], v[74:75], v[74:75]
    v_pk_mul_f32 v[32:33], v[76:77], v[76:77]
    v_pk_mul_f32 v[34:35], v[78:79], v[78:79]
    v_pk_mul_f32 v[36:37], v[80:81], v[80:81]
    v_pk_mul_f32 v[38:39], v[82:83], v[82:83]
    v_pk_fma_f32 v[24:25], v[24:25], v[12:13], v[8:9]
    v_pk_fma_f32 v[26:27], v[26:27], v[12:13], v[8:9]
    v_pk_fma_f32 v[28:29], v[28:29], v[12:13], v[8:9]
    v_pk_fma_f32 v[30:31], v[30:31], v[12:13], v[8:9]
    v_pk_fma_f32 v[32:33], v[32:33], v[12:13], v[8:9]
    v_pk_fma_f32 v[34:35], v[34:35], v[12:13], v[8:9]
    v_pk_fma_f32 v[36:37], v[36:37], v[12:13], v[8:9]
    v_pk_fma_f32 v[38:39], v[38:39], v[12:13], v[8:9]
    v_pk_mul_f32 v[24:25], v[24:25], v[68:69]
    v_pk_mul_f32 v[26:27], v[26:27], v[70:71]
    v_pk_mul_f32 v[28:29], v[28:29], v[72:73]
    v_pk_mul_f32 v[30:31], v[30:31], v[74:75]
    v_pk_mul_f32 v[32:33], v[32:33], v[76:77]
    v_pk_mul_f32 v[34:35], v[34:35], v[78:79]
    v_pk_mul_f32 v[36:37], v[36:37], v[80:81]
    v_exp_f32 v24, v24
    v_pk_mul_f32 v[38:39], v[38:39], v[82:83]
    v_pk_mul_f32 v[44:45], v[84:85], v[84:85]
    v_exp_f32 v25, v25
    v_pk_mul_f32 v[46:47], v[86:87], v[86:87]
    v_exp_f32 v26, v26
    v_pk_fma_f32 v[24:25], v[24:25], v[20:21], v[20:21]
    v_pk_mul_f32 v[48:49], v[88:89], v[88:89]
    v_exp_f32 v27, v27
    v_pk_mul_f32 v[50:51], v[90:91], v[90:91]
    v_exp_f32 v28, v28
    v_pk_fma_f32 v[26:27], v[26:27], v[20:21], v[20:21]
    v_pk_mul_f32 v[52:53], v[92:93], v[92:93]
    v_exp_f32 v29, v29
    v_pk_mul_f32 v[54:55], v[94:95], v[94:95]
    v_exp_f32 v30, v30
    v_pk_fma_f32 v[28:29], v[28:29], v[20:21], v[20:21]
    v_pk_mul_f32 v[56:57], v[96:97], v[96:97]
    v_exp_f32 v31, v31
    v_pk_mul_f32 v[58:59], v[98:99], v[98:99]
    v_exp_f32 v32, v32
    v_pk_fma_f32 v[30:31], v[30:31], v[20:21], v[20:21]
    v_pk_fma_f32 v[44:45], v[44:45], v[14:15], v[10:11]
    v_exp_f32 v33, v33
    v_pk_fma_f32 v[46:47], v[46:47], v[14:15], v[10:11]
    v_exp_f32 v34, v34
    v_pk_fma_f32 v[32:33], v[32:33], v[20:21], v[20:21]
    v_pk_fma_f32 v[48:49], v[48:49], v[14:15], v[10:11]
    v_exp_f32 v35, v35
    v_pk_fma_f32 v[50:51], v[50:51], v[14:15], v[10:11]
    v_exp_f32 v36, v36
    v_pk_fma_f32 v[34:35], v[34:35], v[20:21], v[20:21]
    v_pk_fma_f32 v[52:53], v[52:53], v[14:15], v[10:11]
    v_exp_f32 v37, v37
    v_pk_fma_f32 v[54:55], v[54:55], v[14:15], v[10:11]
    v_exp_f32 v38, v38
    v_pk_fma_f32 v[36:37], v[36:37], v[20:21], v[20:21]
    v_pk_fma_f32 v[56:57], v[56:57], v[14:15], v[10:11]
    v_exp_f32 v39, v39
    v_pk_fma_f32 v[58:59], v[58:59], v[14:15], v[10:11]
    v_rcp_f32 v24, v24
    v_pk_fma_f32 v[38:39], v[38:39], v[20:21], v[20:21]
    v_pk_mul_f32 v[44:45], v[44:45], v[84:85]
    v_rcp_f32 v25, v25
    v_pk_mul_f32 v[46:47], v[46:47], v[86:87]
    v_rcp_f32 v26, v26
    v_pk_mul_f32 v[68:69], v[68:69], v[24:25]
    v_pk_mul_f32 v[48:49], v[48:49], v[88:89]
    v_rcp_f32 v27, v27
    v_cvt_pk_bf16_f32 v180, v68, v69
    v_rcp_f32 v28, v28
    v_pk_mul_f32 v[70:71], v[70:71], v[26:27]
    v_pk_mul_f32 v[50:51], v[50:51], v[90:91]
    v_rcp_f32 v29, v29
    v_cvt_pk_bf16_f32 v181, v70, v71
    v_rcp_f32 v30, v30
    v_pk_mul_f32 v[72:73], v[72:73], v[28:29]
    v_pk_mul_f32 v[52:53], v[52:53], v[92:93]
    v_rcp_f32 v31, v31
    v_cvt_pk_bf16_f32 v182, v72, v73
    v_rcp_f32 v32, v32
    v_pk_mul_f32 v[74:75], v[74:75], v[30:31]
    v_pk_mul_f32 v[54:55], v[54:55], v[94:95]
    v_rcp_f32 v33, v33
    v_cvt_pk_bf16_f32 v183, v74, v75
    v_rcp_f32 v34, v34
    v_pk_mul_f32 v[76:77], v[76:77], v[32:33]
    ds_write_b128 v16, v[180:183] offset:0
    v_rcp_f32 v35, v35
    v_cvt_pk_bf16_f32 v184, v76, v77
    v_rcp_f32 v36, v36
    v_pk_mul_f32 v[78:79], v[78:79], v[34:35]
    v_pk_mul_f32 v[56:57], v[56:57], v[96:97]
    v_rcp_f32 v37, v37
    v_cvt_pk_bf16_f32 v185, v78, v79
    v_rcp_f32 v38, v38
    v_pk_mul_f32 v[80:81], v[80:81], v[36:37]
    v_pk_mul_f32 v[58:59], v[58:59], v[98:99]
    v_rcp_f32 v39, v39
    v_cvt_pk_bf16_f32 v186, v80, v81
    v_exp_f32 v44, v44
    v_pk_mul_f32 v[82:83], v[82:83], v[38:39]
    v_pk_mul_f32 v[24:25], v[100:101], v[100:101]
    v_exp_f32 v45, v45
    v_cvt_pk_bf16_f32 v187, v82, v83
    v_exp_f32 v46, v46
    v_pk_fma_f32 v[44:45], v[44:45], v[22:23], v[22:23]
    ds_write_b128 v16, v[184:187] offset:4096
    v_exp_f32 v47, v47
    v_pk_mul_f32 v[26:27], v[102:103], v[102:103]
    v_exp_f32 v48, v48
    v_pk_fma_f32 v[46:47], v[46:47], v[22:23], v[22:23]
    v_pk_mul_f32 v[28:29], v[104:105], v[104:105]
    v_exp_f32 v49, v49
    v_pk_mul_f32 v[30:31], v[106:107], v[106:107]
    v_exp_f32 v50, v50
    v_pk_fma_f32 v[48:49], v[48:49], v[22:23], v[22:23]
    v_pk_mul_f32 v[32:33], v[108:109], v[108:109]
    v_exp_f32 v51, v51
    v_pk_mul_f32 v[34:35], v[110:111], v[110:111]
    v_exp_f32 v52, v52
    v_pk_fma_f32 v[50:51], v[50:51], v[22:23], v[22:23]
    v_pk_mul_f32 v[36:37], v[112:113], v[112:113]
    v_exp_f32 v53, v53
    v_pk_mul_f32 v[38:39], v[114:115], v[114:115]
    v_exp_f32 v54, v54
    v_pk_fma_f32 v[52:53], v[52:53], v[22:23], v[22:23]
    v_pk_fma_f32 v[24:25], v[24:25], v[12:13], v[8:9]
    v_exp_f32 v55, v55
    v_pk_fma_f32 v[26:27], v[26:27], v[12:13], v[8:9]
    v_exp_f32 v56, v56
    v_pk_fma_f32 v[54:55], v[54:55], v[22:23], v[22:23]
    v_pk_fma_f32 v[28:29], v[28:29], v[12:13], v[8:9]
    v_exp_f32 v57, v57
    v_pk_fma_f32 v[30:31], v[30:31], v[12:13], v[8:9]
    v_exp_f32 v58, v58
    v_pk_fma_f32 v[56:57], v[56:57], v[22:23], v[22:23]
    v_pk_fma_f32 v[32:33], v[32:33], v[12:13], v[8:9]
    v_exp_f32 v59, v59
    v_pk_fma_f32 v[34:35], v[34:35], v[12:13], v[8:9]
    v_rcp_f32 v44, v44
    v_pk_fma_f32 v[58:59], v[58:59], v[22:23], v[22:23]
    v_pk_fma_f32 v[36:37], v[36:37], v[12:13], v[8:9]
    v_rcp_f32 v45, v45
    v_pk_fma_f32 v[38:39], v[38:39], v[12:13], v[8:9]
    v_rcp_f32 v46, v46
    v_pk_mul_f32 v[84:85], v[84:85], v[44:45]
    v_pk_mul_f32 v[24:25], v[24:25], v[100:101]
    v_rcp_f32 v47, v47
    v_cvt_pk_bf16_f32 v188, v84, v85
    v_rcp_f32 v48, v48
PAD_mf_2:
    s_cbranch_execz PAD_mf_3
    v_pk_mul_f32 v[86:87], v[86:87], v[46:47]
    v_pk_mul_f32 v[26:27], v[26:27], v[102:103]
    v_rcp_f32 v49, v49
    v_cvt_pk_bf16_f32 v189, v86, v87
    v_rcp_f32 v50, v50
    v_pk_mul_f32 v[88:89], v[88:89], v[48:49]
    v_pk_mul_f32 v[28:29], v[28:29], v[104:105]
    v_rcp_f32 v51, v51
    v_cvt_pk_bf16_f32 v190, v88, v89
    v_rcp_f32 v52, v52
    v_pk_mul_f32 v[90:91], v[90:91], v[50:51]
    v_pk_mul_f32 v[30:31], v[30:31], v[106:107]
    v_rcp_f32 v53, v53
    v_cvt_pk_bf16_f32 v191, v90, v91
    v_rcp_f32 v54, v54
    v_pk_mul_f32 v[92:93], v[92:93], v[52:53]
    ds_write_b128 v16, v[188:191] offset:8192
    v_rcp_f32 v55, v55
    v_cvt_pk_bf16_f32 v192, v92, v93
    v_rcp_f32 v56, v56
    v_pk_mul_f32 v[94:95], v[94:95], v[54:55]
    v_pk_mul_f32 v[32:33], v[32:33], v[108:109]
    v_rcp_f32 v57, v57
    v_cvt_pk_bf16_f32 v193, v94, v95
    v_rcp_f32 v58, v58
    v_pk_mul_f32 v[96:97], v[96:97], v[56:57]
    v_pk_mul_f32 v[34:35], v[34:35], v[110:111]
    v_rcp_f32 v59, v59
    v_cvt_pk_bf16_f32 v194, v96, v97
    v_exp_f32 v24, v24
    v_pk_mul_f32 v[98:99], v[98:99], v[58:59]
    v_pk_mul_f32 v[36:37], v[36:37], v[112:113]
    v_exp_f32 v25, v25
    v_cvt_pk_bf16_f32 v195, v98, v99
    v_exp_f32 v26, v26
    v_pk_fma_f32 v[24:25], v[24:25], v[20:21], v[20:21]
    ds_write_b128 v16, v[192:195] offset:12288
    v_exp_f32 v27, v27
    v_pk_mul_f32 v[38:39], v[38:39], v[114:115]
    v_exp_f32 v28, v28
    v_pk_fma_f32 v[26:27], v[26:27], v[20:21], v[20:21]
    v_pk_mul_f32 v[44:45], v[116:117], v[116:117]
    v_exp_f32 v29, v29
    v_pk_mul_f32 v[46:47], v[118:119], v[118:119]
    v_exp_f32 v30, v30
    v_pk_fma_f32 v[28:29], v[28:29], v[20:21], v[20:21]
    v_pk_mul_f32 v[48:49], v[120:121], v[120:121]
    v_exp_f32 v31, v31
    v_pk_mul_f32 v[50:51], v[122:123], v[122:123]
    v_exp_f32 v32, v32
    v_pk_fma_f32 v[30:31], v[30:31], v[20:21], v[20:21]
    v_pk_mul_f32 v[52:53], v[124:125], v[124:125]
    v_exp_f32 v33, v33
    v_pk_mul_f32 v[54:55], v[126:127], v[126:127]
    v_exp_f32 v34, v34
    v_pk_fma_f32 v[32:33], v[32:33], v[20:21], v[20:21]
    v_pk_mul_f32 v[56:57], v[128:129], v[128:129]
    v_exp_f32 v35, v35
    v_pk_mul_f32 v[58:59], v[130:131], v[130:131]
    v_exp_f32 v36, v36
    v_pk_fma_f32 v[34:35], v[34:35], v[20:21], v[20:21]
    v_pk_fma_f32 v[44:45], v[44:45], v[14:15], v[10:11]
    v_exp_f32 v37, v37
    v_pk_fma_f32 v[46:47], v[46:47], v[14:15], v[10:11]
    v_exp_f32 v38, v38
    v_pk_fma_f32 v[36:37], v[36:37], v[20:21], v[20:21]
    v_pk_fma_f32 v[48:49], v[48:49], v[14:15], v[10:11]
    v_exp_f32 v39, v39
    v_pk_fma_f32 v[50:51], v[50:51], v[14:15], v[10:11]
    v_rcp_f32 v24, v24
    v_pk_fma_f32 v[38:39], v[38:39], v[20:21], v[20:21]
    v_pk_fma_f32 v[52:53], v[52:53], v[14:15], v[10:11]
    v_rcp_f32 v25, v25
    v_pk_fma_f32 v[54:55], v[54:55], v[14:15], v[10:11]
    v_rcp_f32 v26, v26
    v_pk_mul_f32 v[100:101], v[100:101], v[24:25]
    v_pk_fma_f32 v[56:57], v[56:57], v[14:15], v[10:11]
    v_rcp_f32 v27, v27
    v_cvt_pk_bf16_f32 v180, v100, v101
    v_rcp_f32 v28, v28
    v_pk_mul_f32 v[102:103], v[102:103], v[26:27]
    v_pk_fma_f32 v[58:59], v[58:59], v[14:15], v[10:11]
    v_rcp_f32 v29, v29
    v_cvt_pk_bf16_f32 v181, v102, v103
    v_rcp_f32 v30, v30
    v_pk_mul_f32 v[104:105], v[104:105], v[28:29]
    v_pk_mul_f32 v[44:45], v[44:45], v[116:117]
    v_rcp_f32 v31, v31
    v_cvt_pk_bf16_f32 v182, v104, v105
    v_rcp_f32 v32, v32
    v_pk_mul_f32 v[106:107], v[106:107], v[30:31]
    v_pk_mul_f32 v[46:47], v[46:47], v[118:119]
    v_rcp_f32 v33, v33
    v_cvt_pk_bf16_f32 v183, v106, v107
    v_rcp_f32 v34, v34
    v_pk_mul_f32 v[108:109], v[108:109], v[32:33]
    ds_write_b128 v16, v[180:183] offset:16384
    v_rcp_f32 v35, v35
    v_cvt_pk_bf16_f32 v184, v108, v109
    v_rcp_f32 v36, v36
    v_pk_mul_f32 v[110:111], v[110:111], v[34:35]
    v_pk_mul_f32 v[48:49], v[48:49], v[120:121]
    v_rcp_f32 v37, v37
    v_cvt_pk_bf16_f32 v185, v110, v111
    v_rcp_f32 v38, v38
    v_pk_mul_f32 v[112:113], v[112:113], v[36:37]
    v_pk_mul_f32 v[50:51], v[50:51], v[122:123]
    v_rcp_f32 v39, v39
    v_cvt_pk_bf16_f32 v186, v112, v113
    v_exp_f32 v44, v44
    v_pk_mul_f32 v[114:115], v[114:115], v[38:39]
    v_pk_mul_f32 v[52:53], v[52:53], v[124:125]
    v_exp_f32 v45, v45
    v_cvt_pk_bf16_f32 v187, v114, v115
    v_exp_f32 v46, v46
    v_pk_fma_f32 v[44:45], v[44:45], v[22:23], v[22:23]
    ds_write_b128 v16, v[184:187] offset:20480
    v_exp_f32 v47, v47
    v_pk_mul_f32 v[54:55], v[54:55], v[126:127]
    v_exp_f32 v48, v48
    s_mov_b64 exec, 1
    ds_add_u32 v241, v19
    s_mov_b64 exec, -1
    v_pk_fma_f32 v[46:47], v[46:47], v[22:23], v[22:23]
    v_exp_f32 v49, v49
    v_pk_mul_f32 v[56:57], v[56:57], v[128:129]
    v_exp_f32 v50, v50
    v_pk_fma_f32 v[48:49], v[48:49], v[22:23], v[22:23]
    v_pk_mul_f32 v[58:59], v[58:59], v[130:131]
    v_exp_f32 v51, v51
    v_pk_mul_f32 v[24:25], v[132:133], v[132:133]
    v_exp_f32 v52, v52
    v_pk_fma_f32 v[50:51], v[50:51], v[22:23], v[22:23]
    v_pk_mul_f32 v[26:27], v[134:135], v[134:135]
    v_exp_f32 v53, v53
    v_pk_mul_f32 v[28:29], v[136:137], v[136:137]
    v_exp_f32 v54, v54
    v_pk_fma_f32 v[52:53], v[52:53], v[22:23], v[22:23]
    v_pk_mul_f32 v[30:31], v[138:139], v[138:139]
    v_exp_f32 v55, v55
    v_pk_mul_f32 v[32:33], v[140:141], v[140:141]
    v_exp_f32 v56, v56
    v_pk_fma_f32 v[54:55], v[54:55], v[22:23], v[22:23]
    v_pk_mul_f32 v[34:35], v[142:143], v[142:143]
    v_exp_f32 v57, v57
    v_pk_mul_f32 v[36:37], v[144:145], v[144:145]
    v_exp_f32 v58, v58
    v_pk_fma_f32 v[56:57], v[56:57], v[22:23], v[22:23]
    v_pk_mul_f32 v[38:39], v[146:147], v[146:147]
    v_exp_f32 v59, v59
    v_pk_fma_f32 v[24:25], v[24:25], v[12:13], v[8:9]
    v_rcp_f32 v44, v44
    v_pk_fma_f32 v[58:59], v[58:59], v[22:23], v[22:23]
    v_pk_fma_f32 v[26:27], v[26:27], v[12:13], v[8:9]
    v_rcp_f32 v45, v45
    v_pk_fma_f32 v[28:29], v[28:29], v[12:13], v[8:9]
    v_rcp_f32 v46, v46
    v_pk_mul_f32 v[116:117], v[116:117], v[44:45]
    v_pk_fma_f32 v[30:31], v[30:31], v[12:13], v[8:9]
    v_rcp_f32 v47, v47
    v_cvt_pk_bf16_f32 v188, v116, v117
    v_rcp_f32 v48, v48
    v_pk_mul_f32 v[118:119], v[118:119], v[46:47]
    v_pk_fma_f32 v[32:33], v[32:33], v[12:13], v[8:9]
    v_rcp_f32 v49, v49
    v_cvt_pk_bf16_f32 v189, v118, v119
    v_rcp_f32 v50, v50
    v_pk_mul_f32 v[120:121], v[120:121], v[48:49]
    v_pk_fma_f32 v[34:35], v[34:35], v[12:13], v[8:9]
    v_rcp_f32 v51, v51
    v_cvt_pk_bf16_f32 v190, v120, v121
    v_rcp_f32 v52, v52
    v_pk_mul_f32 v[122:123], v[122:123], v[50:51]
PAD_mf_3:
    s_cbranch_execz PAD_mf_4
    v_pk_fma_f32 v[36:37], v[36:37], v[12:13], v[8:9]
    v_rcp_f32 v53, v53
    v_cvt_pk_bf16_f32 v191, v122, v123
    v_rcp_f32 v54, v54
    v_pk_mul_f32 v[124:125], v[124:125], v[52:53]
    ds_write_b128 v16, v[188:191] offset:24576
    v_rcp_f32 v55, v55
    v_cvt_pk_bf16_f32 v192, v124, v125
    v_rcp_f32 v56, v56
    v_pk_mul_f32 v[126:127], v[126:127], v[54:55]
    v_pk_fma_f32 v[38:39], v[38:39], v[12:13], v[8:9]
    v_rcp_f32 v57, v57
    v_cvt_pk_bf16_f32 v193, v126, v127
    v_rcp_f32 v58, v58
    v_pk_mul_f32 v[128:129], v[128:129], v[56:57]
    v_pk_mul_f32 v[24:25], v[24:25], v[132:133]
    v_rcp_f32 v59, v59
    v_cvt_pk_bf16_f32 v194, v128, v129
    v_exp_f32 v24, v24
    v_pk_mul_f32 v[130:131], v[130:131], v[58:59]
    v_pk_mul_f32 v[26:27], v[26:27], v[134:135]
    v_exp_f32 v25, v25
    v_cvt_pk_bf16_f32 v195, v130, v131
    v_exp_f32 v26, v26
    v_pk_fma_f32 v[24:25], v[24:25], v[20:21], v[20:21]
    ds_write_b128 v16, v[192:195] offset:28672
    v_exp_f32 v27, v27
    v_pk_mul_f32 v[28:29], v[28:29], v[136:137]
    v_pk_mul_f32 v[30:31], v[30:31], v[138:139]
    v_pk_fma_f32 v[26:27], v[26:27], v[20:21], v[20:21]
    v_exp_f32 v28, v28
    v_pk_mul_f32 v[32:33], v[32:33], v[140:141]
    v_exp_f32 v29, v29
    v_pk_mul_f32 v[34:35], v[34:35], v[142:143]
    v_exp_f32 v30, v30
    v_pk_fma_f32 v[28:29], v[28:29], v[20:21], v[20:21]
    v_exp_f32 v31, v31
    v_pk_mul_f32 v[36:37], v[36:37], v[144:145]
    v_exp_f32 v32, v32
    v_pk_fma_f32 v[30:31], v[30:31], v[20:21], v[20:21]
    v_pk_mul_f32 v[38:39], v[38:39], v[146:147]
    v_exp_f32 v33, v33
    v_pk_mul_f32 v[44:45], v[148:149], v[148:149]
    v_exp_f32 v34, v34
    v_pk_fma_f32 v[32:33], v[32:33], v[20:21], v[20:21]
    v_pk_mul_f32 v[46:47], v[150:151], v[150:151]
    v_exp_f32 v35, v35
    v_pk_mul_f32 v[48:49], v[152:153], v[152:153]
    v_exp_f32 v36, v36
    v_pk_fma_f32 v[34:35], v[34:35], v[20:21], v[20:21]
    v_pk_mul_f32 v[50:51], v[154:155], v[154:155]
    v_exp_f32 v37, v37
    v_pk_mul_f32 v[52:53], v[156:157], v[156:157]
    v_exp_f32 v38, v38
    v_pk_fma_f32 v[36:37], v[36:37], v[20:21], v[20:21]
    v_pk_mul_f32 v[54:55], v[158:159], v[158:159]
    v_exp_f32 v39, v39
    v_pk_mul_f32 v[56:57], v[160:161], v[160:161]
    v_rcp_f32 v24, v24
    v_pk_fma_f32 v[38:39], v[38:39], v[20:21], v[20:21]
    v_pk_mul_f32 v[58:59], v[162:163], v[162:163]
    v_rcp_f32 v25, v25
    v_pk_fma_f32 v[44:45], v[44:45], v[14:15], v[10:11]
    v_rcp_f32 v26, v26
    v_pk_mul_f32 v[132:133], v[132:133], v[24:25]
    v_pk_fma_f32 v[46:47], v[46:47], v[14:15], v[10:11]
    v_rcp_f32 v27, v27
    v_cvt_pk_bf16_f32 v180, v132, v133
    v_rcp_f32 v28, v28
    v_pk_mul_f32 v[134:135], v[134:135], v[26:27]
    v_pk_fma_f32 v[48:49], v[48:49], v[14:15], v[10:11]
    v_rcp_f32 v29, v29
    v_cvt_pk_bf16_f32 v181, v134, v135
    v_rcp_f32 v30, v30
    v_pk_mul_f32 v[136:137], v[136:137], v[28:29]
    v_pk_fma_f32 v[50:51], v[50:51], v[14:15], v[10:11]
    v_rcp_f32 v31, v31
    v_cvt_pk_bf16_f32 v182, v136, v137
    v_rcp_f32 v32, v32
    v_pk_mul_f32 v[138:139], v[138:139], v[30:31]
    v_pk_fma_f32 v[52:53], v[52:53], v[14:15], v[10:11]
    v_rcp_f32 v33, v33
    v_cvt_pk_bf16_f32 v183, v138, v139
    v_rcp_f32 v34, v34
    v_pk_mul_f32 v[140:141], v[140:141], v[32:33]
    ds_write_b128 v17, v[180:183] offset:0
    v_rcp_f32 v35, v35
    v_cvt_pk_bf16_f32 v184, v140, v141
    v_rcp_f32 v36, v36
    v_pk_mul_f32 v[142:143], v[142:143], v[34:35]
    v_pk_fma_f32 v[54:55], v[54:55], v[14:15], v[10:11]
    v_rcp_f32 v37, v37
    v_cvt_pk_bf16_f32 v185, v142, v143
    v_rcp_f32 v38, v38
    v_pk_mul_f32 v[144:145], v[144:145], v[36:37]
    v_pk_fma_f32 v[56:57], v[56:57], v[14:15], v[10:11]
    v_rcp_f32 v39, v39
    v_cvt_pk_bf16_f32 v186, v144, v145
    v_pk_fma_f32 v[58:59], v[58:59], v[14:15], v[10:11]
    v_pk_mul_f32 v[146:147], v[146:147], v[38:39]
    v_pk_mul_f32 v[44:45], v[44:45], v[148:149]
    v_pk_mul_f32 v[46:47], v[46:47], v[150:151]
    v_cvt_pk_bf16_f32 v187, v146, v147
    v_exp_f32 v44, v44
    v_pk_mul_f32 v[48:49], v[48:49], v[152:153]
    v_exp_f32 v45, v45
    ds_write_b128 v17, v[184:187] offset:4224
    v_exp_f32 v46, v46
    v_pk_fma_f32 v[44:45], v[44:45], v[22:23], v[22:23]
    v_exp_f32 v47, v47
    v_pk_mul_f32 v[50:51], v[50:51], v[154:155]
    v_exp_f32 v48, v48
    v_pk_fma_f32 v[46:47], v[46:47], v[22:23], v[22:23]
    v_exp_f32 v49, v49
    v_pk_mul_f32 v[52:53], v[52:53], v[156:157]
    v_exp_f32 v50, v50
    v_pk_fma_f32 v[48:49], v[48:49], v[22:23], v[22:23]
    v_exp_f32 v51, v51
    v_pk_mul_f32 v[54:55], v[54:55], v[158:159]
    v_exp_f32 v52, v52
    v_pk_fma_f32 v[50:51], v[50:51], v[22:23], v[22:23]
    v_exp_f32 v53, v53
    v_pk_mul_f32 v[56:57], v[56:57], v[160:161]
    v_exp_f32 v54, v54
    v_pk_fma_f32 v[52:53], v[52:53], v[22:23], v[22:23]
    v_pk_mul_f32 v[58:59], v[58:59], v[162:163]
    v_exp_f32 v55, v55
    v_pk_mul_f32 v[24:25], v[164:165], v[164:165]
    v_exp_f32 v56, v56
    v_pk_fma_f32 v[54:55], v[54:55], v[22:23], v[22:23]
    v_pk_mul_f32 v[26:27], v[166:167], v[166:167]
    v_exp_f32 v57, v57
    v_pk_mul_f32 v[28:29], v[168:169], v[168:169]
    v_exp_f32 v58, v58
    v_pk_fma_f32 v[56:57], v[56:57], v[22:23], v[22:23]
    v_pk_mul_f32 v[30:31], v[170:171], v[170:171]
    v_exp_f32 v59, v59
    v_pk_mul_f32 v[32:33], v[172:173], v[172:173]
    v_rcp_f32 v44, v44
    v_pk_fma_f32 v[58:59], v[58:59], v[22:23], v[22:23]
    v_pk_mul_f32 v[34:35], v[174:175], v[174:175]
    v_rcp_f32 v45, v45
    v_pk_mul_f32 v[36:37], v[176:177], v[176:177]
    v_rcp_f32 v46, v46
    v_pk_mul_f32 v[148:149], v[148:149], v[44:45]
    v_pk_mul_f32 v[38:39], v[178:179], v[178:179]
    v_rcp_f32 v47, v47
    v_cvt_pk_bf16_f32 v188, v148, v149
    v_rcp_f32 v48, v48
    v_pk_mul_f32 v[150:151], v[150:151], v[46:47]
    v_pk_fma_f32 v[24:25], v[24:25], v[12:13], v[8:9]
    v_rcp_f32 v49, v49
    v_cvt_pk_bf16_f32 v189, v150, v151
    v_rcp_f32 v50, v50
    v_pk_mul_f32 v[152:153], v[152:153], v[48:49]
    v_pk_fma_f32 v[26:27], v[26:27], v[12:13], v[8:9]
    v_rcp_f32 v51, v51
    v_cvt_pk_bf16_f32 v190, v152, v153
    v_rcp_f32 v52, v52
    v_pk_mul_f32 v[154:155], v[154:155], v[50:51]
    v_pk_fma_f32 v[28:29], v[28:29], v[12:13], v[8:9]
    v_rcp_f32 v53, v53
    v_cvt_pk_bf16_f32 v191, v154, v155
    v_rcp_f32 v54, v54
    v_pk_mul_f32 v[156:157], v[156:157], v[52:53]
    ds_write_b128 v17, v[188:191] offset:8448
    v_rcp_f32 v55, v55
    v_cvt_pk_bf16_f32 v192, v156, v157
    v_rcp_f32 v56, v56
    v_pk_mul_f32 v[158:159], v[158:159], v[54:55]
    v_pk_fma_f32 v[30:31], v[30:31], v[12:13], v[8:9]
    v_rcp_f32 v57, v57
PAD_mf_4:
    s_cbranch_execz L_tour_ret
    v_cvt_pk_bf16_f32 v193, v158, v159
    v_rcp_f32 v58, v58
    v_pk_mul_f32 v[160:161], v[160:161], v[56:57]
    v_pk_fma_f32 v[32:33], v[32:33], v[12:13], v[8:9]
    v_rcp_f32 v59, v59
    v_cvt_pk_bf16_f32 v194, v160, v161
    v_pk_fma_f32 v[34:35], v[34:35], v[12:13], v[8:9]
    v_pk_mul_f32 v[162:163], v[162:163], v[58:59]
    v_pk_fma_f32 v[36:37], v[36:37], v[12:13], v[8:9]
    v_pk_fma_f32 v[38:39], v[38:39], v[12:13], v[8:9]
    v_cvt_pk_bf16_f32 v195, v162, v163
    v_pk_mul_f32 v[24:25], v[24:25], v[164:165]
    v_pk_mul_f32 v[26:27], v[26:27], v[166:167]
    ds_write_b128 v17, v[192:195] offset:12672
    v_exp_f32 v24, v24
    v_pk_mul_f32 v[28:29], v[28:29], v[168:169]
    v_exp_f32 v25, v25
    v_pk_mul_f32 v[30:31], v[30:31], v[170:171]
    v_exp_f32 v26, v26
    v_pk_fma_f32 v[24:25], v[24:25], v[20:21], v[20:21]
    v_exp_f32 v27, v27
    v_pk_mul_f32 v[32:33], v[32:33], v[172:173]
    v_exp_f32 v28, v28
    v_pk_fma_f32 v[26:27], v[26:27], v[20:21], v[20:21]
    v_exp_f32 v29, v29
    v_pk_mul_f32 v[34:35], v[34:35], v[174:175]
    v_exp_f32 v30, v30
    v_pk_fma_f32 v[28:29], v[28:29], v[20:21], v[20:21]
    v_exp_f32 v31, v31
    v_pk_mul_f32 v[36:37], v[36:37], v[176:177]
    v_exp_f32 v32, v32
    v_pk_fma_f32 v[30:31], v[30:31], v[20:21], v[20:21]
    v_exp_f32 v33, v33
    v_pk_mul_f32 v[38:39], v[38:39], v[178:179]
    v_exp_f32 v34, v34
    v_pk_fma_f32 v[32:33], v[32:33], v[20:21], v[20:21]
    v_exp_f32 v35, v35
    v_exp_f32 v36, v36
    v_exp_f32 v37, v37
    v_pk_fma_f32 v[34:35], v[34:35], v[20:21], v[20:21]
    v_exp_f32 v38, v38
    v_pk_fma_f32 v[36:37], v[36:37], v[20:21], v[20:21]
    v_exp_f32 v39, v39
    v_rcp_f32 v24, v24
    v_rcp_f32 v25, v25
    v_pk_fma_f32 v[38:39], v[38:39], v[20:21], v[20:21]
    v_rcp_f32 v26, v26
    v_pk_mul_f32 v[164:165], v[164:165], v[24:25]
    v_rcp_f32 v27, v27
    v_rcp_f32 v28, v28
    v_cvt_pk_bf16_f32 v180, v164, v165
    v_pk_mul_f32 v[166:167], v[166:167], v[26:27]
    v_rcp_f32 v29, v29
    v_rcp_f32 v30, v30
    v_cvt_pk_bf16_f32 v181, v166, v167
    v_pk_mul_f32 v[168:169], v[168:169], v[28:29]
    v_rcp_f32 v31, v31
    v_rcp_f32 v32, v32
    v_cvt_pk_bf16_f32 v182, v168, v169
    v_pk_mul_f32 v[170:171], v[170:171], v[30:31]
    v_rcp_f32 v33, v33
    v_rcp_f32 v34, v34
    v_cvt_pk_bf16_f32 v183, v170, v171
    v_pk_mul_f32 v[172:173], v[172:173], v[32:33]
    v_rcp_f32 v35, v35
    ds_write_b128 v17, v[180:183] offset:16896
    v_cvt_pk_bf16_f32 v184, v172, v173
    v_pk_mul_f32 v[174:175], v[174:175], v[34:35]
    v_rcp_f32 v36, v36
    v_rcp_f32 v37, v37
    v_cvt_pk_bf16_f32 v185, v174, v175
    v_rcp_f32 v38, v38
    v_pk_mul_f32 v[176:177], v[176:177], v[36:37]
    v_rcp_f32 v39, v39
    s_nop 0
    v_cvt_pk_bf16_f32 v186, v176, v177
    v_pk_mul_f32 v[178:179], v[178:179], v[38:39]
    s_nop 0
    s_nop 0
    v_cvt_pk_bf16_f32 v187, v178, v179
    s_nop 0
    s_nop 0
    ds_write_b128 v17, v[184:187] offset:21120
L_a:
TOUR_a:
    s_cbranch_execz PAD_a_1
    v_mov_b64 v[96:97], 0
    v_mov_b64 v[98:99], 0
    v_mov_b64 v[100:101], 0
    v_mov_b64 v[102:103], 0
    v_mov_b64 v[104:105], 0
    v_mov_b64 v[106:107], 0
    v_mov_b64 v[108:109], 0
    v_mov_b64 v[110:111], 0
    v_mov_b64 v[112:113], 0
    v_mov_b64 v[114:115], 0
    v_mov_b64 v[116:117], 0
    v_mov_b64 v[118:119], 0
    v_mov_b64 v[120:121], 0
    v_mov_b64 v[122:123], 0
    v_mov_b64 v[124:125], 0
    v_mov_b64 v[126:127], 0
    v_mov_b64 v[44:45], 0
    v_mov_b64 v[46:47], 0
    v_mov_b64 v[184:185], 0
    v_mov_b64 v[186:187], 0
    v_mov_b64 v[188:189], 0
    v_mov_b64 v[190:191], 0
    v_mov_b32 v60, 0xdddd
L_a_wait0:
    ds_read_b32 v59, v248
    s_waitcnt lgkmcnt(0)
    v_readfirstlane_b32 s74, v59
    s_cmp_lg_u32 s74, 4
    s_cbranch_scc1 L_a_wait0
    ds_read_b128 v[28:31], v244
    ds_read_b128 v[20:23], v249
    ds_read_b128 v[24:27], v249 offset:1024
    ds_read_b128 v[32:35], v244 offset:1024
    ds_read_b128 v[36:39], v245
    ds_read_b128 v[40:43], v246
    s_waitcnt lgkmcnt(3)
    v_mfma_f32_32x32x16_bf16 v[128:143], v[28:31], v[20:23], 0
    v_mfma_f32_32x32x16_bf16 v[144:159], v[28:31], v[24:27], 0
    ds_write_b32 v18, v19
    s_nop 10
    v_max3_f32 v56, v128, v129, v130
    v_max3_f32 v56, v56, v131, v132
    v_max3_f32 v56, v56, v133, v134
    v_max3_f32 v56, v56, v135, v136
    v_max3_f32 v56, v56, v137, v138
    v_max3_f32 v56, v56, v139, v140
    v_max3_f32 v56, v56, v141, v142
    v_max_f32 v56, v56, v143
    v_mov_b32 v57, v56
    s_nop 1
    v_permlane32_swap_b32 v56, v57
    s_nop 1
    v_max_f32 v56, v56, v57
    v_sub_f32 v64, 0, v56
    v_sub_f32 v65, 0, v56
    v_mov_b64 v[66:67], v[64:65]
    v_mov_b64 v[68:69], v[64:65]
    v_mov_b64 v[70:71], v[64:65]
    v_mov_b64 v[72:73], v[64:65]
    v_mov_b64 v[74:75], v[64:65]
    v_mov_b64 v[76:77], v[64:65]
    v_mov_b64 v[78:79], v[64:65]
    s_nop 1
    v_mfma_f32_32x32x16_bf16 v[128:143], v[28:31], v[20:23], v[64:79]
    v_max3_f32 v56, v144, v145, v146
    v_max3_f32 v56, v56, v147, v148
    v_max3_f32 v56, v56, v149, v150
    v_max3_f32 v56, v56, v151, v152
    v_max3_f32 v56, v56, v153, v154
    v_max3_f32 v56, v56, v155, v156
    v_max3_f32 v56, v56, v157, v158
    v_max_f32 v56, v56, v159
    v_mov_b32 v57, v56
    s_nop 1
    v_permlane32_swap_b32 v56, v57
    s_nop 1
    v_max_f32 v56, v56, v57
    v_sub_f32 v80, 0, v56
    v_sub_f32 v81, 0, v56
    v_mov_b64 v[82:83], v[80:81]
    v_mov_b64 v[84:85], v[80:81]
    v_mov_b64 v[86:87], v[80:81]
    v_mov_b64 v[88:89], v[80:81]
    v_mov_b64 v[90:91], v[80:81]
    v_mov_b64 v[92:93], v[80:81]
    v_mov_b64 v[94:95], v[80:81]
    s_mov_b32 s11, 8
    s_waitcnt lgkmcnt(0)
.p2align 6
L_a_loop:
    v_mfma_f32_32x32x16_bf16 v[144:159], v[28:31], v[24:27], v[80:95]
    v_exp_f32 v160, v128
    v_exp_f32 v161, v129
    v_exp_f32 v162, v130
    v_exp_f32 v163, v131
    v_exp_f32 v164, v132
    v_smfmac_f32_32x32x32_bf16 v[112:127], v[44:47], v[184:191], v60
    s_waitcnt lgkmcnt(0)
    v_exp_f32 v165, v133
    v_exp_f32 v166, v134
    v_exp_f32 v167, v135
    v_exp_f32 v168, v136
    v_exp_f32 v169, v137
    v_smfmac_f32_32x32x32_bf16 v[96:111], v[36:39], v[160:167], v60
    ds_read_b128 v[28:31], v244 offset:2048
    v_exp_f32 v170, v138
    v_exp_f32 v171, v139
    v_exp_f32 v172, v140
    v_exp_f32 v173, v141
    v_exp_f32 v174, v142
    v_exp_f32 v175, v143
    v_mfma_f32_32x32x16_bf16 v[128:143], v[32:35], v[20:23], v[64:79]
    v_exp_f32 v176, v144
    v_exp_f32 v177, v145
    v_exp_f32 v178, v146
    v_exp_f32 v179, v147
    v_exp_f32 v180, v148
    v_smfmac_f32_32x32x32_bf16 v[96:111], v[40:43], v[168:175], v60
    ds_read_b128 v[44:47], v246 offset:1056
    v_exp_f32 v181, v149
    v_exp_f32 v182, v150
    v_exp_f32 v183, v151
    v_exp_f32 v184, v152
    v_exp_f32 v185, v153
    v_smfmac_f32_32x32x32_bf16 v[112:127], v[36:39], v[176:183], v60
    ds_read_b128 v[36:39], v245 offset:1056
    v_exp_f32 v186, v154
    v_exp_f32 v187, v155
    v_exp_f32 v188, v156
    v_exp_f32 v189, v157
    v_exp_f32 v190, v158
    v_exp_f32 v191, v159
    v_mfma_f32_32x32x16_bf16 v[144:159], v[32:35], v[24:27], v[80:95]
    v_exp_f32 v160, v128
    v_exp_f32 v161, v129
    v_exp_f32 v162, v130
    v_exp_f32 v163, v131
    v_exp_f32 v164, v132
    v_smfmac_f32_32x32x32_bf16 v[112:127], v[40:43], v[184:191], v60
    s_waitcnt lgkmcnt(0)
    v_exp_f32 v165, v133
    v_exp_f32 v166, v134
    v_exp_f32 v167, v135
    v_exp_f32 v168, v136
    v_exp_f32 v169, v137
    v_smfmac_f32_32x32x32_bf16 v[96:111], v[36:39], v[160:167], v60
    ds_read_b128 v[32:35], v244 offset:3072
    v_exp_f32 v170, v138
    v_exp_f32 v171, v139
    v_exp_f32 v172, v140
    v_exp_f32 v173, v141
    v_exp_f32 v174, v142
    v_exp_f32 v175, v143
    v_mfma_f32_32x32x16_bf16 v[128:143], v[28:31], v[20:23], v[64:79]
    v_exp_f32 v176, v144
    v_exp_f32 v177, v145
    v_exp_f32 v178, v146
    v_exp_f32 v179, v147
    v_exp_f32 v180, v148
    v_smfmac_f32_32x32x32_bf16 v[96:111], v[44:47], v[168:175], v60
    ds_read_b128 v[40:43], v246 offset:2112
    v_exp_f32 v181, v149
    v_exp_f32 v182, v150
    v_exp_f32 v183, v151
    v_exp_f32 v184, v152
    v_exp_f32 v185, v153
    v_smfmac_f32_32x32x32_bf16 v[112:127], v[36:39], v[176:183], v60
    ds_read_b128 v[36:39], v245 offset:2112
    v_exp_f32 v186, v154
    v_exp_f32 v187, v155
    v_exp_f32 v188, v156
    v_exp_f32 v189, v157
    v_exp_f32 v190, v158
    v_exp_f32 v191, v159
    v_mfma_f32_32x32x16_bf16 v[144:159], v[28:31], v[24:27], v[80:95]
    v_exp_f32 v160, v128
    v_exp_f32 v161, v129
    v_exp_f32 v162, v130
    v_exp_f32 v163, v131
    v_exp_f32 v164, v132
    v_smfmac_f32_32x32x32_bf16 v[112:127], v[44:47], v[184:191], v60
    s_waitcnt lgkmcnt(0)
    v_exp_f32 v165, v133
    v_exp_f32 v166, v134
    v_exp_f32 v167, v135
    v_exp_f32 v168, v136
    v_exp_f32 v169, v137
    v_smfmac_f32_32x32x32_bf16 v[96:111], v[36:39], v[160:167], v60
    ds_read_b128 v[28:31], v244 offset:4096
    v_exp_f32 v170, v138
    v_exp_f32 v171, v139
    v_exp_f32 v172, v140
    v_exp_f32 v173, v141
    v_exp_f32 v174, v142
    v_exp_f32 v175, v143
    v_mfma_f32_32x32x16_bf16 v[128:143], v[32:35], v[20:23], v[64:79]
    v_exp_f32 v176, v144
    v_exp_f32 v177, v145
    v_exp_f32 v178, v146
    v_exp_f32 v179, v147
    v_exp_f32 v180, v148
    v_smfmac_f32_32x32x32_bf16 v[96:111], v[40:43], v[168:175], v60
    ds_read_b128 v[44:47], v246 offset:3168
    v_exp_f32 v181, v149
    v_exp_f32 v182, v150
    v_exp_f32 v183, v151
    v_exp_f32 v184, v152
    v_exp_f32 v185, v153
    v_smfmac_f32_32x32x32_bf16 v[112:127], v[36:39], v[176:183], v60
    ds_read_b128 v[36:39], v245 offset:3168
    v_exp_f32 v186, v154
    v_exp_f32 v187, v155
    v_exp_f32 v188, v156
    v_exp_f32 v189, v157
    v_exp_f32 v190, v158
    v_exp_f32 v191, v159
    v_mfma_f32_32x32x16_bf16 v[144:159], v[32:35], v[24:27], v[80:95]
    v_exp_f32 v160, v128
    v_exp_f32 v161, v129
    v_exp_f32 v162, v130
    v_exp_f32 v163, v131
    v_exp_f32 v164, v132
    v_smfmac_f32_32x32x32_bf16 v[112:127], v[40:43], v[184:191], v60
    s_waitcnt lgkmcnt(0)
    v_exp_f32 v165, v133
    v_exp_f32 v166, v134
    v_exp_f32 v167, v135
    v_exp_f32 v168, v136
    v_exp_f32 v169, v137
    v_smfmac_f32_32x32x32_bf16 v[96:111], v[36:39], v[160:167], v60
    ds_read_b128 v[32:35], v244 offset:5120
    v_exp_f32 v170, v138
    v_exp_f32 v171, v139
    v_exp_f32 v172, v140
    v_exp_f32 v173, v141
    v_exp_f32 v174, v142
    v_exp_f32 v175, v143
    v_mfma_f32_32x32x16_bf16 v[128:143], v[28:31], v[20:23], v[64:79]
PAD_a_1:
    s_cbranch_execz PAD_a_2
    v_exp_f32 v176, v144
    v_exp_f32 v177, v145
    v_exp_f32 v178, v146
    v_exp_f32 v179, v147
    v_exp_f32 v180, v148
    v_smfmac_f32_32x32x32_bf16 v[96:111], v[44:47], v[168:175], v60
    ds_read_b128 v[40:43], v246 offset:4224
    v_exp_f32 v181, v149
    v_exp_f32 v182, v150
    v_exp_f32 v183, v151
    v_exp_f32 v184, v152
    v_exp_f32 v185, v153
    v_smfmac_f32_32x32x32_bf16 v[112:127], v[36:39], v[176:183], v60
    ds_read_b128 v[36:39], v245 offset:4224
    v_exp_f32 v186, v154
    v_exp_f32 v187, v155
    v_exp_f32 v188, v156
    v_exp_f32 v189, v157
    v_exp_f32 v190, v158
    v_exp_f32 v191, v159
    v_mfma_f32_32x32x16_bf16 v[144:159], v[28:31], v[24:27], v[80:95]
    v_exp_f32 v160, v128
    v_exp_f32 v161, v129
    v_exp_f32 v162, v130
    v_exp_f32 v163, v131
    v_exp_f32 v164, v132
    v_smfmac_f32_32x32x32_bf16 v[112:127], v[44:47], v[184:191], v60
    s_waitcnt lgkmcnt(0)
    v_exp_f32 v165, v133
    v_exp_f32 v166, v134
    v_exp_f32 v167, v135
    v_exp_f32 v168, v136
    v_exp_f32 v169, v137
    v_smfmac_f32_32x32x32_bf16 v[96:111], v[36:39], v[160:167], v60
    ds_read_b128 v[28:31], v244 offset:6144
    v_exp_f32 v170, v138
    v_exp_f32 v171, v139
    v_exp_f32 v172, v140
    v_exp_f32 v173, v141
    v_exp_f32 v174, v142
    v_exp_f32 v175, v143
    v_mfma_f32_32x32x16_bf16 v[128:143], v[32:35], v[20:23], v[64:79]
    v_exp_f32 v176, v144
    v_exp_f32 v177, v145
    v_exp_f32 v178, v146
    v_exp_f32 v179, v147
    v_exp_f32 v180, v148
    v_smfmac_f32_32x32x32_bf16 v[96:111], v[40:43], v[168:175], v60
    ds_read_b128 v[44:47], v246 offset:5280
    v_exp_f32 v181, v149
    v_exp_f32 v182, v150
    v_exp_f32 v183, v151
    v_exp_f32 v184, v152
    v_exp_f32 v185, v153
    v_smfmac_f32_32x32x32_bf16 v[112:127], v[36:39], v[176:183], v60
    ds_read_b128 v[36:39], v245 offset:5280
    v_exp_f32 v186, v154
    v_exp_f32 v187, v155
    v_exp_f32 v188, v156
    v_exp_f32 v189, v157
    v_exp_f32 v190, v158
    v_exp_f32 v191, v159
    v_mfma_f32_32x32x16_bf16 v[144:159], v[32:35], v[24:27], v[80:95]
    v_exp_f32 v160, v128
    v_exp_f32 v161, v129
    v_exp_f32 v162, v130
    v_exp_f32 v163, v131
    v_exp_f32 v164, v132
    v_smfmac_f32_32x32x32_bf16 v[112:127], v[40:43], v[184:191], v60
    s_waitcnt lgkmcnt(0)
    v_exp_f32 v165, v133
    v_exp_f32 v166, v134
    v_exp_f32 v167, v135
    v_exp_f32 v168, v136
    v_exp_f32 v169, v137
    v_smfmac_f32_32x32x32_bf16 v[96:111], v[36:39], v[160:167], v60
    ds_read_b128 v[32:35], v244 offset:7168
    v_exp_f32 v170, v138
    v_exp_f32 v171, v139
    v_exp_f32 v172, v140
    v_exp_f32 v173, v141
    v_exp_f32 v174, v142
    v_exp_f32 v175, v143
    v_mfma_f32_32x32x16_bf16 v[128:143], v[28:31], v[20:23], v[64:79]
    ds_read_b32 v59, v248 offset:4
    v_exp_f32 v176, v144
    v_exp_f32 v177, v145
    v_exp_f32 v178, v146
    v_exp_f32 v179, v147
    v_exp_f32 v180, v148
    v_smfmac_f32_32x32x32_bf16 v[96:111], v[44:47], v[168:175], v60
    ds_read_b128 v[40:43], v246 offset:6336
    v_exp_f32 v181, v149
    v_exp_f32 v182, v150
    v_exp_f32 v183, v151
    v_exp_f32 v184, v152
    v_exp_f32 v185, v153
    v_smfmac_f32_32x32x32_bf16 v[112:127], v[36:39], v[176:183], v60
    ds_read_b128 v[36:39], v245 offset:6336
    v_exp_f32 v186, v154
    v_exp_f32 v187, v155
    v_exp_f32 v188, v156
    v_exp_f32 v189, v157
    v_exp_f32 v190, v158
    v_exp_f32 v191, v159
    v_mfma_f32_32x32x16_bf16 v[144:159], v[28:31], v[24:27], v[80:95]
    v_exp_f32 v160, v128
    v_exp_f32 v161, v129
    v_exp_f32 v162, v130
    v_exp_f32 v163, v131
    v_exp_f32 v164, v132
    v_smfmac_f32_32x32x32_bf16 v[112:127], v[44:47], v[184:191], v60
    s_waitcnt lgkmcnt(0)
    v_exp_f32 v165, v133
    v_exp_f32 v166, v134
    v_exp_f32 v167, v135
    v_readfirstlane_b32 s74, v59
    v_exp_f32 v168, v136
    v_exp_f32 v169, v137
    v_smfmac_f32_32x32x32_bf16 v[96:111], v[36:39], v[160:167], v60
    s_cmp_lg_u32 s74, 4
    s_cbranch_scc1 L_a_spin
L_a_spun:
    ds_read_b128 v[28:31], v244 offset:8192
    v_exp_f32 v170, v138
    v_exp_f32 v171, v139
    v_exp_f32 v172, v140
    v_exp_f32 v173, v141
    v_exp_f32 v174, v142
    v_exp_f32 v175, v143
    v_mfma_f32_32x32x16_bf16 v[128:143], v[32:35], v[20:23], v[64:79]
    v_exp_f32 v176, v144
    v_exp_f32 v177, v145
    v_exp_f32 v178, v146
    v_exp_f32 v179, v147
    v_exp_f32 v180, v148
    v_smfmac_f32_32x32x32_bf16 v[96:111], v[40:43], v[168:175], v60
    ds_read_b128 v[44:47], v246 offset:7392
    v_exp_f32 v181, v149
    v_exp_f32 v182, v150
    v_exp_f32 v183, v151
    v_exp_f32 v184, v152
    v_exp_f32 v185, v153
    v_smfmac_f32_32x32x32_bf16 v[112:127], v[36:39], v[176:183], v60
    ds_read_b128 v[36:39], v245 offset:7392
    v_exp_f32 v186, v154
    v_exp_f32 v187, v155
    v_exp_f32 v188, v156
    v_exp_f32 v189, v157
    v_exp_f32 v190, v158
    v_exp_f32 v191, v159
    v_mfma_f32_32x32x16_bf16 v[144:159], v[32:35], v[24:27], v[80:95]
    v_exp_f32 v160, v128
    v_exp_f32 v161, v129
    v_exp_f32 v162, v130
    v_exp_f32 v163, v131
    v_exp_f32 v164, v132
    v_smfmac_f32_32x32x32_bf16 v[112:127], v[40:43], v[184:191], v60
    s_waitcnt lgkmcnt(0)
    v_exp_f32 v165, v133
    v_exp_f32 v166, v134
    v_exp_f32 v167, v135
    v_exp_f32 v168, v136
    v_exp_f32 v169, v137
    v_smfmac_f32_32x32x32_bf16 v[96:111], v[36:39], v[160:167], v60
    ds_read_b128 v[32:35], v244 offset:9216
    v_exp_f32 v170, v138
    v_exp_f32 v171, v139
    v_exp_f32 v172, v140
    v_exp_f32 v173, v141
    v_exp_f32 v174, v142
    v_exp_f32 v175, v143
    v_mfma_f32_32x32x16_bf16 v[128:143], v[28:31], v[20:23], v[64:79]
    s_sub_u32 s11, s11, 1
    v_exp_f32 v176, v144
    v_exp_f32 v177, v145
    v_exp_f32 v178, v146
    v_exp_f32 v179, v147
    v_exp_f32 v180, v148
    v_smfmac_f32_32x32x32_bf16 v[96:111], v[44:47], v[168:175], v60
    ds_read_b128 v[40:43], v246 offset:8448
    v_exp_f32 v181, v149
    v_exp_f32 v182, v150
    v_exp_f32 v183, v151
    v_exp_f32 v184, v152
    v_exp_f32 v185, v153
    v_smfmac_f32_32x32x32_bf16 v[112:127], v[36:39], v[176:183], v60
    ds_read_b128 v[36:39], v245 offset:8448
    v_exp_f32 v186, v154
    v_exp_f32 v187, v155
    v_exp_f32 v188, v156
    v_exp_f32 v189, v157
    v_exp_f32 v190, v158
    v_exp_f32 v191, v159
    v_add_u32 v244, 8192, v244
    v_add_u32 v245, 8448, v245
    v_add_u32 v246, 8448, v246
    v_add_u32 v248, 4, v248
    s_cmp_lg_u32 s11, 0
    s_cbranch_scc1 L_a_loop
    v_smfmac_f32_32x32x32_bf16 v[112:127], v[44:47], v[184:191], v60
    buffer_load_dwordx4 v[8:11], v5, s[52:55], 0 offen
    buffer_load_dwordx4 v[12:15], v6, s[56:59], 0 offen
    s_nop 1
    v_add_f32 v56, abs(v96), abs(v97)
    v_add_f32 v56, v56, abs(v98)
    v_add_f32 v56, v56, abs(v99)
    v_add_f32 v56, v56, abs(v100)
    v_add_f32 v56, v56, abs(v101)
    v_add_f32 v56, v56, abs(v102)
    v_add_f32 v56, v56, abs(v103)
    v_add_f32 v56, v56, abs(v104)
    v_add_f32 v56, v56, abs(v112)
    v_add_f32 v56, v56, abs(v113)
    v_add_f32 v56, v56, abs(v114)
    v_add_f32 v56, v56, abs(v115)
    v_add_f32 v56, v56, abs(v116)
PAD_a_2:
    s_cbranch_execz L_tour_ret
    v_add_f32 v56, v56, abs(v117)
    v_add_f32 v56, v56, abs(v118)
    v_add_f32 v56, v56, abs(v119)
    v_add_f32 v56, v56, abs(v120)
    v_mov_b32 v57, 0x7f000000
    v_cmp_lt_f32 vcc, v56, v57
    s_nop 4
    s_cmp_eq_u64 vcc, -1
    s_cbranch_scc0 L_fallback
L_a_fin:
    v_rcp_f32 v56, v104
    v_rcp_f32 v57, v120
    v_mul_f32 v96, v96, v56
    v_mul_f32 v97, v97, v56
    v_mul_f32 v98, v98, v56
    v_mul_f32 v99, v99, v56
    v_mul_f32 v100, v100, v56
    v_mul_f32 v101, v101, v56
    v_mul_f32 v102, v102, v56
    v_mul_f32 v103, v103, v56
    v_cvt_pk_bf16_f32 v48, v96, v97
    v_cvt_pk_bf16_f32 v49, v98, v99
    v_cvt_pk_bf16_f32 v50, v100, v101
    v_cvt_pk_bf16_f32 v51, v102, v103
    v_min_u32 v48, -2, v48
    v_min_u32 v49, -2, v49
    v_min_u32 v50, -2, v50
    v_min_u32 v51, -2, v51
    buffer_store_dwordx4 v[48:51], v3, s[28:31], s8 offen sc1
    v_mul_f32 v112, v112, v57
    v_mul_f32 v113, v113, v57
    v_mul_f32 v114, v114, v57
    v_mul_f32 v115, v115, v57
    v_mul_f32 v116, v116, v57
    v_mul_f32 v117, v117, v57
    v_mul_f32 v118, v118, v57
    v_mul_f32 v119, v119, v57
    v_cvt_pk_bf16_f32 v52, v112, v113
    v_cvt_pk_bf16_f32 v53, v114, v115
    v_cvt_pk_bf16_f32 v54, v116, v117
    v_cvt_pk_bf16_f32 v55, v118, v119
    v_min_u32 v52, -2, v52
    v_min_u32 v53, -2, v53
    v_min_u32 v54, -2, v54
    v_min_u32 v55, -2, v55
    buffer_store_dwordx4 v[52:55], v3, s[28:31], s9 offen sc1
    s_mov_b64 exec, 1
    ds_add_u32 v241, v19 offset:4
    s_mov_b64 exec, -1
    s_waitcnt vmcnt(2)
    s_branch L_final
L_a_spin:
    ds_read_b32 v59, v248 offset:4
    s_waitcnt lgkmcnt(0)
    v_readfirstlane_b32 s74, v59
    s_cmp_lg_u32 s74, 4
    s_cbranch_scc1 L_a_spin
    s_branch L_a_spun
L_code_end:
L_fallback:
    s_waitcnt lgkmcnt(0)
    s_lshl_b32 s74, s69, 16
    s_add_u32 s75, s74, 2097152
    s_add_u32 s84, s24, s75
    s_addc_u32 s85, s25, 0
    s_mov_b32 s86, 0x10000
    s_mov_b32 s87, 0x00020000
    s_add_u32 s75, s74, 4194304
    s_add_u32 s88, s24, s75
    s_addc_u32 s89, s25, 0
    s_mov_b32 s90, 0x10000
    s_mov_b32 s91, 0x00020000
    v_mov_b32 v64, 0xff7fffff
    v_mov_b32 v80, 0xff7fffff
    v_mov_b32 v36, 0x3f803f80
    s_mov_b32 s12, 0x0000ffff
    s_mov_b32 s13, 0x0000ffff
    v_mov_b32 v37, v36
    v_mov_b32 v38, v36
    v_mov_b32 v39, v36
    v_mov_b32 v40, v36
    v_mov_b32 v41, v36
    v_mov_b32 v42, v36
    v_mov_b32 v43, v36
    v_mov_b32 v96, 0
    v_mov_b32 v97, 0
    v_mov_b32 v98, 0
    v_mov_b32 v99, 0
    v_mov_b32 v100, 0
    v_mov_b32 v101, 0
    v_mov_b32 v102, 0
    v_mov_b32 v103, 0
    v_mov_b32 v104, 0
    v_mov_b32 v105, 0
    v_mov_b32 v106, 0
    v_mov_b32 v107, 0
    v_mov_b32 v108, 0
    v_mov_b32 v109, 0
    v_mov_b32 v110, 0
    v_mov_b32 v111, 0
    v_mov_b32 v112, 0
    v_mov_b32 v113, 0
    v_mov_b32 v114, 0
    v_mov_b32 v115, 0
    v_mov_b32 v116, 0
    v_mov_b32 v117, 0
    v_mov_b32 v118, 0
    v_mov_b32 v119, 0
    v_mov_b32 v120, 0
    v_mov_b32 v121, 0
    v_mov_b32 v122, 0
    v_mov_b32 v123, 0
    v_mov_b32 v124, 0
    v_mov_b32 v125, 0
    v_mov_b32 v126, 0
    v_mov_b32 v127, 0
    s_mov_b32 s11, 0
L_fb_loop:
    buffer_load_dwordx4 v[28:31], v3, s[84:87], s11 offen sc1
    s_mov_b64 exec, s[12:13]
    buffer_load_dwordx4 v[36:39], v247, s[88:91], s11 offen sc1
    buffer_load_dwordx4 v[40:43], v247, s[88:91], s11 offen offset:512 sc1
    s_mov_b64 exec, -1
    s_waitcnt vmcnt(0)
    v_mfma_f32_32x32x16_bf16 v[128:143], v[28:31], v[20:23], 0
    s_nop 15
    s_nop 3
    v_max3_f32 v56, v128, v129, v130
    v_max3_f32 v56, v56, v131, v132
    v_max3_f32 v56, v56, v133, v134
    v_max3_f32 v56, v56, v135, v136
    v_max3_f32 v56, v56, v137, v138
    v_max3_f32 v56, v56, v139, v140
    v_max3_f32 v56, v56, v141, v142
    v_max_f32 v56, v56, v143
    v_mov_b32 v57, v56
    s_nop 1
    v_permlane32_swap_b32 v56, v57
    s_nop 1
    v_max_f32 v56, v56, v57
    v_max_f32 v56, v56, v64
    v_sub_f32 v58, v64, v56
    v_exp_f32 v58, v58
    v_mov_b32 v64, v56
    v_mul_f32 v96, v96, v58
    v_mul_f32 v97, v97, v58
    v_mul_f32 v98, v98, v58
    v_mul_f32 v99, v99, v58
    v_mul_f32 v100, v100, v58
    v_mul_f32 v101, v101, v58
    v_mul_f32 v102, v102, v58
    v_mul_f32 v103, v103, v58
    v_mul_f32 v104, v104, v58
    v_mul_f32 v105, v105, v58
    v_mul_f32 v106, v106, v58
    v_mul_f32 v107, v107, v58
    v_mul_f32 v108, v108, v58
    v_mul_f32 v109, v109, v58
    v_mul_f32 v110, v110, v58
    v_mul_f32 v111, v111, v58
    v_sub_f32 v128, v128, v56
    v_sub_f32 v129, v129, v56
    v_sub_f32 v130, v130, v56
    v_sub_f32 v131, v131, v56
    v_sub_f32 v132, v132, v56
    v_sub_f32 v133, v133, v56
    v_sub_f32 v134, v134, v56
    v_sub_f32 v135, v135, v56
    v_sub_f32 v136, v136, v56
    v_sub_f32 v137, v137, v56
    v_sub_f32 v138, v138, v56
    v_sub_f32 v139, v139, v56
    v_sub_f32 v140, v140, v56
    v_sub_f32 v141, v141, v56
    v_sub_f32 v142, v142, v56
    v_sub_f32 v143, v143, v56
    v_exp_f32 v128, v128
    v_exp_f32 v129, v129
    v_exp_f32 v130, v130
    v_exp_f32 v131, v131
    v_exp_f32 v132, v132
    v_exp_f32 v133, v133
    v_exp_f32 v134, v134
    v_exp_f32 v135, v135
    v_exp_f32 v136, v136
    v_exp_f32 v137, v137
    v_exp_f32 v138, v138
    v_exp_f32 v139, v139
    v_exp_f32 v140, v140
    v_exp_f32 v141, v141
    v_exp_f32 v142, v142
    v_exp_f32 v143, v143
    s_nop 0
    v_cvt_pk_bf16_f32 v48, v128, v129
    v_cvt_pk_bf16_f32 v49, v130, v131
    v_cvt_pk_bf16_f32 v50, v132, v133
    v_cvt_pk_bf16_f32 v51, v134, v135
    v_cvt_pk_bf16_f32 v52, v136, v137
    v_cvt_pk_bf16_f32 v53, v138, v139
    v_cvt_pk_bf16_f32 v54, v140, v141
    v_cvt_pk_bf16_f32 v55, v142, v143
    s_nop 1
    v_mfma_f32_32x32x16_bf16 v[96:111], v[36:39], v[48:51], v[96:111]
    v_mfma_f32_32x32x16_bf16 v[96:111], v[40:43], v[52:55], v[96:111]
    v_mfma_f32_32x32x16_bf16 v[128:143], v[28:31], v[24:27], 0
    s_nop 15
    s_nop 3
    v_max3_f32 v56, v128, v129, v130
    v_max3_f32 v56, v56, v131, v132
    v_max3_f32 v56, v56, v133, v134
    v_max3_f32 v56, v56, v135, v136
    v_max3_f32 v56, v56, v137, v138
    v_max3_f32 v56, v56, v139, v140
    v_max3_f32 v56, v56, v141, v142
    v_max_f32 v56, v56, v143
    v_mov_b32 v57, v56
    s_nop 1
    v_permlane32_swap_b32 v56, v57
    s_nop 1
    v_max_f32 v56, v56, v57
    v_max_f32 v56, v56, v80
    v_sub_f32 v58, v80, v56
    v_exp_f32 v58, v58
    v_mov_b32 v80, v56
    v_mul_f32 v112, v112, v58
    v_mul_f32 v113, v113, v58
    v_mul_f32 v114, v114, v58
    v_mul_f32 v115, v115, v58
    v_mul_f32 v116, v116, v58
    v_mul_f32 v117, v117, v58
    v_mul_f32 v118, v118, v58
    v_mul_f32 v119, v119, v58
    v_mul_f32 v120, v120, v58
    v_mul_f32 v121, v121, v58
    v_mul_f32 v122, v122, v58
    v_mul_f32 v123, v123, v58
    v_mul_f32 v124, v124, v58
    v_mul_f32 v125, v125, v58
    v_mul_f32 v126, v126, v58
    v_mul_f32 v127, v127, v58
    v_sub_f32 v128, v128, v56
    v_sub_f32 v129, v129, v56
    v_sub_f32 v130, v130, v56
    v_sub_f32 v131, v131, v56
    v_sub_f32 v132, v132, v56
    v_sub_f32 v133, v133, v56
    v_sub_f32 v134, v134, v56
    v_sub_f32 v135, v135, v56
    v_sub_f32 v136, v136, v56
    v_sub_f32 v137, v137, v56
    v_sub_f32 v138, v138, v56
    v_sub_f32 v139, v139, v56
    v_sub_f32 v140, v140, v56
    v_sub_f32 v141, v141, v56
    v_sub_f32 v142, v142, v56
    v_sub_f32 v143, v143, v56
    v_exp_f32 v128, v128
    v_exp_f32 v129, v129
    v_exp_f32 v130, v130
    v_exp_f32 v131, v131
    v_exp_f32 v132, v132
    v_exp_f32 v133, v133
    v_exp_f32 v134, v134
    v_exp_f32 v135, v135
    v_exp_f32 v136, v136
    v_exp_f32 v137, v137
    v_exp_f32 v138, v138
    v_exp_f32 v139, v139
    v_exp_f32 v140, v140
    v_exp_f32 v141, v141
    v_exp_f32 v142, v142
    v_exp_f32 v143, v143
    s_nop 0
    v_cvt_pk_bf16_f32 v48, v128, v129
    v_cvt_pk_bf16_f32 v49, v130, v131
    v_cvt_pk_bf16_f32 v50, v132, v133
    v_cvt_pk_bf16_f32 v51, v134, v135
    v_cvt_pk_bf16_f32 v52, v136, v137
    v_cvt_pk_bf16_f32 v53, v138, v139
    v_cvt_pk_bf16_f32 v54, v140, v141
    v_cvt_pk_bf16_f32 v55, v142, v143
    s_nop 1
    v_mfma_f32_32x32x16_bf16 v[112:127], v[36:39], v[48:51], v[112:127]
    v_mfma_f32_32x32x16_bf16 v[112:127], v[40:43], v[52:55], v[112:127]
    s_nop 15
    s_nop 3
    s_add_u32 s11, s11, 1024
    s_cmp_lt_u32 s11, 0x10000
    s_cbranch_scc1 L_fb_loop
    s_branch L_a_fin
.section .rodata,"a"
.p2align 6
.amdhsa_kernel parallel_sum__softmax_full_mha__dense_activation_gelu__prompt_kernel
  .amdhsa_next_free_vgpr 256
  .amdhsa_next_free_sgpr 102
  .amdhsa_accum_offset 256
  .amdhsa_group_segment_fixed_size 0
  .amdhsa_kernarg_size 88
  .amdhsa_user_sgpr_count 2
  .amdhsa_user_sgpr_kernarg_segment_ptr 1
  .amdhsa_system_sgpr_workgroup_id_x 1
.end_amdhsa_kernel
```
